```python
import torch

def _softmax(x, axis=-1):
    return torch.softmax(x, dim=axis)
def _gelu(x):
    return torch.nn.functional.gelu(x, approximate="tanh")
def _silu(x):
    return torch.nn.functional.silu(x)
def _sigmoid(x):
    return torch.sigmoid(x)
def _layernorm(x, axis=-1, eps=1e-5):
    m = x.mean(dim=axis, keepdim=True)
    v = x.var(dim=axis, keepdim=True, unbiased=False)
    return (x - m) / torch.sqrt(v + eps)
def _scatter_add(tgt, idx, src, axis=0):
    return tgt.clone().index_add_(axis, idx, src)
def _segment_sum(src, seg, n):
    out = torch.zeros((n,) + src.shape[1:], dtype=src.dtype)
    return out.index_add_(0, seg, src)
def _pad(x, pw):
    flat = tuple(v for pair in reversed(pw) for v in pair)
    return torch.nn.functional.pad(x, flat)

kernel_name = 'gated_mix__sliding_block_cached__gqa_block_cached__decode'

def setup_inputs():

    _w = (lambda a: (lambda t: t.to(torch.bfloat16) if t.is_floating_point() else t)(torch.as_tensor(a)))
    def _A_setup():
        B, Sq, D = 4, 1, 512
        Hq, Hkv, Sk, Dh = 32, 8, 8192, 128
        assert Hq % Hkv == 0, (Hq, Hkv)
        return {
            "x": _w((lambda *s: torch.randn(*s, dtype=torch.bfloat16) * 0.05)(B, Sq, D)),
            "k_cache": _w((lambda *s: torch.randn(*s, dtype=torch.bfloat16) * 6.4)(B, Hkv, Sk, Dh)),
            "v_cache": _w((lambda *s: torch.randn(*s, dtype=torch.bfloat16) * 0.05)(B, Hkv, Sk, Dh)),
            "wq": _w((lambda *s: torch.randn(*s, dtype=torch.bfloat16) * 6.4)(D, Hq * Dh) * (D ** -0.5)),
            "wo": _w((lambda *s: torch.randn(*s, dtype=torch.bfloat16) * 0.05)(Hq * Dh, D) * ((Hq * Dh) ** -0.5)),
        }
    _A_in = _A_setup()

    def _B_setup():
        B, Sq, D = 4, 1, 512
        Hq, Hkv, Sk, Dh = 32, 8, 8192, 128
        assert Hq % Hkv == 0, (Hq, Hkv)
        return {
            "x": _w((lambda *s: torch.randn(*s, dtype=torch.bfloat16) * 0.05)(B, Sq, D)),
            "k_cache": _w((lambda *s: torch.randn(*s, dtype=torch.bfloat16) * 6.4)(B, Hkv, Sk, Dh)),
            "v_cache": _w((lambda *s: torch.randn(*s, dtype=torch.bfloat16) * 0.05)(B, Hkv, Sk, Dh)),
            "wq": _w((lambda *s: torch.randn(*s, dtype=torch.bfloat16) * 6.4)(D, Hq * Dh) * (D ** -0.5)),
            "wo": _w((lambda *s: torch.randn(*s, dtype=torch.bfloat16) * 0.05)(Hq * Dh, D) * ((Hq * Dh) ** -0.5)),
        }
    _B_in = _B_setup()

    return {
        "A_x": _A_in["x"],
        "A_k_cache": _A_in["k_cache"],
        "A_v_cache": _A_in["v_cache"],
        "A_wq": _A_in["wq"],
        "A_wo": _A_in["wo"],
        "B_x": _B_in["x"],
        "B_k_cache": _B_in["k_cache"],
        "B_v_cache": _B_in["v_cache"],
        "B_wq": _B_in["wq"],
        "B_wo": _B_in["wo"],
        "gate_w": _w((lambda *s: torch.randn(*s, dtype=torch.bfloat16) * 0.05)(512) * 16.0),
    }

def reference(A_x, A_k_cache, A_v_cache, A_wq, A_wo, B_x, B_k_cache, B_v_cache, B_wq, B_wo, gate_w):
    def _A_ref(x, k_cache, v_cache, wq, wo):
        B, Sq, D = x.shape
        Hq, Dh = 32, 128
        Hkv, Sk = k_cache.shape[1], k_cache.shape[2]
        W = min(4096, max(256, Sk // 4))
        rep = Hq // Hkv
        q = (lambda x, *d: x.permute(*d))((x @ wq).reshape(B, Sq, Hq, Dh), 0, 2, 1, 3)
        k = (lambda x, n, axis: torch.repeat_interleave(x, n, dim=axis))(k_cache[:, :, Sk - W:, :], rep, axis=1)
        v = (lambda x, n, axis: torch.repeat_interleave(x, n, dim=axis))(v_cache[:, :, Sk - W:, :], rep, axis=1)
        scores = torch.einsum("bhqd,bhkd->bhqk", q, k) * (Dh ** -0.5)
        p = _softmax(scores, axis=-1)
        o = torch.einsum("bhqk,bhkd->bhqd", p, v)
        return (lambda x, *d: x.permute(*d))(o, 0, 2, 1, 3).reshape(B, Sq, Hq * Dh) @ wo

    def _B_ref(x, k_cache, v_cache, wq, wo):
        B, Sq, D = x.shape
        Hq, Dh = 32, 128
        Hkv = k_cache.shape[1]
        rep = Hq // Hkv
        q = (lambda x, *d: x.permute(*d))((x @ wq).reshape(B, Sq, Hq, Dh), 0, 2, 1, 3)
        k = (lambda x, n, axis: torch.repeat_interleave(x, n, dim=axis))(k_cache, rep, axis=1)
        v = (lambda x, n, axis: torch.repeat_interleave(x, n, dim=axis))(v_cache, rep, axis=1)
        scores = torch.einsum("bhqd,bhkd->bhqk", q, k) * (Dh ** -0.5)
        p = _softmax(scores, axis=-1)
        o = torch.einsum("bhqk,bhkd->bhqd", p, v)
        return (lambda x, *d: x.permute(*d))(o, 0, 2, 1, 3).reshape(B, Sq, Hq * Dh) @ wo

    x = A_x
    g = _sigmoid((x * gate_w).sum(-1, keepdims=True))
    a = _A_ref(x, A_k_cache, A_v_cache, A_wq, A_wo)
    b = _B_ref(x, B_k_cache, B_v_cache, B_wq, B_wo)
    return g * a + (1 - g) * b
```

```asm
; @launch grid=(256,1,1) block=(256,1,1) lds=19216
.amdgcn_target "amdgcn-amd-amdhsa--gfx950"
.text
.globl gated_mix__sliding_block_cached__gqa_block_cached__decode_kernel
.p2align 8
.type gated_mix__sliding_block_cached__gqa_block_cached__decode_kernel,@function
gated_mix__sliding_block_cached__gqa_block_cached__decode_kernel:
    s_cmp_ge_u32 s2, 256
    s_cbranch_scc1 L_end
    s_load_dwordx16 s[4:19], s[0:1], 0
    s_load_dwordx8 s[20:27], s[0:1], 64
    s_load_dwordx4 s[28:31], s[0:1], 96
    s_getpc_b64 s[68:69]
L_pc:
    s_mov_b32 s70, L_end-L_pc
    s_mov_b32 s71, 0x20000
    v_lshlrev_b32 v224, 4, v0
    s_mov_b32 s91, 0
    buffer_load_dwordx4 v[228:231], v224, s[68:71], s91 offen
    s_mov_b32 s91, 4096
    buffer_load_dwordx4 v[232:235], v224, s[68:71], s91 offen
    s_mov_b32 s91, 8192
    buffer_load_dwordx4 v[236:239], v224, s[68:71], s91 offen
    s_mov_b32 s91, 12288
    buffer_load_dwordx4 v[240:243], v224, s[68:71], s91 offen
    s_mov_b32 s91, 16384
    buffer_load_dwordx4 v[244:247], v224, s[68:71], s91 offen
    v_lshrrev_b32 v4, 6, v0
    v_and_b32 v1, 63, v0
    s_and_b32 s81, s2, 7
    s_lshr_b32 s82, s2, 3
    v_readfirstlane_b32 s78, v4
    s_lshr_b32 s79, s82, 3
    s_and_b32 s80, s82, 7
    s_and_b32 s99, s81, 3
    s_lshl_b32 s99, s99, 2
    s_add_u32 s99, s99, s79
    v_and_b32 v4, 3, v1
    v_lshrrev_b32 v5, 2, v1
    v_lshlrev_b32 v6, 10, v4
    v_lshl_add_u32 v6, v5, 6, v6
    v_lshlrev_b32 v7, 4, v4
    v_lshl_add_u32 v7, v5, 18, v7
    v_lshlrev_b32 v3, 4, v1
    s_lshl_b32 s92, s80, 10
    s_lshl_b32 s93, s99, 6
    s_add_u32 s92, s92, s93
    s_lshl_b32 s93, s78, 16
    s_add_u32 s92, s92, s93
    s_lshl_b32 s91, s78, 4
    s_lshl_b32 s94, s79, 10
    s_lshl_b32 s97, s81, 2
    s_add_u32 s97, s97, s78
    s_mov_b32 s62, 4096
    s_mov_b32 s63, 0x20000
    s_mov_b32 s66, 0x400000
    s_mov_b32 s67, 0x20000
    s_mov_b32 s74, 1024
    s_mov_b32 s75, 0x20000
    s_mov_b32 s50, 0x800000
    s_mov_b32 s51, 0x20000
    s_lshl_b32 s87, s82, 8
    s_add_u32 s87, s87, 4096
    v_bfrev_b32 v21, 2
    v_cmp_eq_u32 vcc, 0, v1
    v_mov_b32 v44, 0
    s_nop 0
    v_cndmask_b32 v21, v21, 0, vcc
    s_cmp_lt_u32 s81, 4
    s_waitcnt lgkmcnt(0)
    s_cselect_b32 s64, s10, s20
    s_cselect_b32 s65, s11, s21
    s_mov_b32 s60, s4
    s_mov_b32 s61, s5
    s_mov_b32 s72, s24
    s_mov_b32 s73, s25
    s_mov_b32 s48, s30
    s_mov_b32 s49, s31
    s_load_dword s76, s[30:31], 0
    s_cmp_lg_u32 s97, 3
    s_cbranch_scc1 L_noinit
    buffer_store_dword v44, v21, s[48:51], s87 offen sc1
L_noinit:
    buffer_load_dwordx4 v[24:27], v6, s[60:63], s91 offen
    buffer_load_dwordx4 v[192:195], v7, s[64:67], s92 offen nt
    s_add_u32 s92, s92, 8192
    buffer_load_dwordx4 v[196:199], v7, s[64:67], s92 offen nt
    s_add_u32 s92, s92, 8192
    buffer_load_dwordx4 v[200:203], v7, s[64:67], s92 offen nt
    s_add_u32 s92, s92, 8192
    buffer_load_dwordx4 v[204:207], v7, s[64:67], s92 offen nt
    s_add_u32 s92, s92, 8192
    buffer_load_dwordx4 v[208:211], v7, s[64:67], s92 offen nt
    s_add_u32 s92, s92, 8192
    buffer_load_dwordx4 v[212:215], v7, s[64:67], s92 offen nt
    s_add_u32 s92, s92, 8192
    buffer_load_dwordx4 v[216:219], v7, s[64:67], s92 offen nt
    s_add_u32 s92, s92, 8192
    buffer_load_dwordx4 v[220:223], v7, s[64:67], s92 offen nt
    buffer_load_dwordx4 v[28:31], v3, s[60:63], s94 offen
    buffer_load_dwordx4 v[40:43], v3, s[72:75], 0 offen
    s_mov_b32 s32, s6
    s_mov_b32 s33, s7
    s_mov_b32 s34, 0x4000000
    s_mov_b32 s35, 0x20000
    s_mov_b32 s36, s8
    s_mov_b32 s37, s9
    s_mov_b32 s38, 0x4000000
    s_mov_b32 s39, 0x20000
    s_mov_b32 s40, s16
    s_mov_b32 s41, s17
    s_mov_b32 s42, 0x4000000
    s_mov_b32 s43, 0x20000
    s_mov_b32 s44, s18
    s_mov_b32 s45, s19
    s_mov_b32 s46, 0x4000000
    s_mov_b32 s47, 0x20000
    s_mov_b32 s52, s12
    s_mov_b32 s53, s13
    s_mov_b32 s54, 0x400000
    s_mov_b32 s55, 0x20000
    s_mov_b32 s56, s22
    s_mov_b32 s57, s23
    s_mov_b32 s58, 0x400000
    s_mov_b32 s59, 0x20000
    s_mov_b32 s68, s26
    s_mov_b32 s69, s27
    s_mov_b32 s70, 0x1000
    s_mov_b32 s71, 0x20000
    s_lshl_b32 s83, s82, 21
    v_and_b32 v2, 3, v1
    v_lshlrev_b32 v2, 4, v2
    v_bfe_u32 v4, v1, 2, 2
    v_lshl_add_u32 v2, v4, 8, v2
    v_lshrrev_b32 v4, 4, v1
    v_lshl_add_u32 v2, v4, 6, v2
    s_mov_b32 s84, 0x3fb8aa3b
    s_mov_b32 s85, 0x05040100
    s_mov_b32 s86, 0x07060302
    s_mov_b32 s95, 0
    s_mov_b32 s96, 0
    s_lshl_b32 s20, s82, 15
    s_add_u32 s21, s20, 1048576
    s_lshl_b32 s93, s78, 13
    s_add_u32 s20, s21, s93
    s_lshl_b32 s93, s81, 10
    s_add_u32 s20, s20, s93
    s_add_u32 s26, s20, 0x100000
    s_lshr_b32 s93, s81, 1
    s_lshl_b32 s92, s93, 13
    s_add_u32 s21, s21, s92
    s_lshl_b32 s92, s78, 20
    s_add_u32 s21, s21, s92
    s_add_u32 s25, s21, 4096
    s_lshl_b32 s92, s80, 2
    s_add_u32 s93, s93, s92
    s_lshl_b32 s3, s93, 17
    s_lshl_b32 s22, s93, 7
    s_and_b32 s92, s81, 1
    s_lshl_b32 s93, s92, 9
    s_add_u32 s3, s3, s93
    s_lshl_b32 s93, s78, 7
    s_add_u32 s3, s3, s93
    s_lshl_b32 s93, s79, 1
    s_add_u32 s92, s92, s93
    s_lshl_b32 s92, s92, 17
    s_add_u32 s22, s22, s92
    s_lshl_b32 s92, s78, 15
    s_add_u32 s22, s22, s92
    s_add_u32 s22, s22, 3145728
    s_lshl_b32 s23, s79, 18
    s_and_b32 s92, s2, 63
    s_lshl_b32 s93, s92, 12
    s_add_u32 s23, s23, s93
    s_add_u32 s23, s23, 3145728
    s_lshl_b32 s24, s79, 10
    s_lshl_b32 s92, s92, 4
    s_add_u32 s24, s24, s92
    s_waitcnt vmcnt(0)
    s_lshl_b32 s89, s97, 12
    s_add_u32 s89, s89, s83
    s_add_u32 s89, s89, 1572864
    buffer_load_dwordx4 a[0:3], v2, s[32:35], s89 offen offset:0 nt
    buffer_load_dwordx4 a[4:7], v2, s[32:35], s89 offen offset:1024 nt
    buffer_load_dwordx4 a[8:11], v2, s[32:35], s89 offen offset:2048 nt
    buffer_load_dwordx4 a[12:15], v2, s[32:35], s89 offen offset:3072 nt
    buffer_load_dwordx4 v[128:131], v3, s[36:39], s89 offen offset:0 nt
    buffer_load_dwordx4 v[132:135], v3, s[36:39], s89 offen offset:1024 nt
    buffer_load_dwordx4 v[136:139], v3, s[36:39], s89 offen offset:2048 nt
    buffer_load_dwordx4 v[140:143], v3, s[36:39], s89 offen offset:3072 nt
    v_perm_b32 v48, v196, v192, s85
    v_perm_b32 v49, v204, v200, s85
    v_perm_b32 v50, v196, v192, s86
    v_perm_b32 v51, v204, v200, s86
    v_perm_b32 v52, v197, v193, s85
    v_perm_b32 v53, v205, v201, s85
    v_perm_b32 v54, v197, v193, s86
    v_perm_b32 v55, v205, v201, s86
    v_perm_b32 v56, v198, v194, s85
    v_perm_b32 v57, v206, v202, s85
    v_perm_b32 v58, v198, v194, s86
    v_perm_b32 v59, v206, v202, s86
    v_perm_b32 v60, v199, v195, s85
    v_perm_b32 v61, v207, v203, s85
    v_perm_b32 v62, v199, v195, s86
    v_perm_b32 v63, v207, v203, s86
    v_mfma_f32_4x4x4_16b_bf16 v[64:67], v[24:25], v[48:49], 0
    v_mfma_f32_4x4x4_16b_bf16 v[68:71], v[24:25], v[50:51], 0
    v_mfma_f32_4x4x4_16b_bf16 v[72:75], v[24:25], v[52:53], 0
    v_mfma_f32_4x4x4_16b_bf16 v[76:79], v[24:25], v[54:55], 0
    v_mfma_f32_4x4x4_16b_bf16 v[80:83], v[24:25], v[56:57], 0
    v_mfma_f32_4x4x4_16b_bf16 v[84:87], v[24:25], v[58:59], 0
    v_mfma_f32_4x4x4_16b_bf16 v[88:91], v[24:25], v[60:61], 0
    v_mfma_f32_4x4x4_16b_bf16 v[92:95], v[24:25], v[62:63], 0
    v_perm_b32 v48, v212, v208, s85
    v_perm_b32 v49, v220, v216, s85
    v_perm_b32 v50, v212, v208, s86
    v_perm_b32 v51, v220, v216, s86
    v_perm_b32 v52, v213, v209, s85
    v_perm_b32 v53, v221, v217, s85
    v_perm_b32 v54, v213, v209, s86
    v_perm_b32 v55, v221, v217, s86
    v_perm_b32 v56, v214, v210, s85
    v_perm_b32 v57, v222, v218, s85
    v_perm_b32 v58, v214, v210, s86
    v_perm_b32 v59, v222, v218, s86
    v_perm_b32 v60, v215, v211, s85
    v_perm_b32 v61, v223, v219, s85
    v_perm_b32 v62, v215, v211, s86
    v_perm_b32 v63, v223, v219, s86
    v_mfma_f32_4x4x4_16b_bf16 v[64:67], v[26:27], v[48:49], v[64:67]
    v_mfma_f32_4x4x4_16b_bf16 v[68:71], v[26:27], v[50:51], v[68:71]
    v_mfma_f32_4x4x4_16b_bf16 v[72:75], v[26:27], v[52:53], v[72:75]
    v_mfma_f32_4x4x4_16b_bf16 v[76:79], v[26:27], v[54:55], v[76:79]
    v_mfma_f32_4x4x4_16b_bf16 v[80:83], v[26:27], v[56:57], v[80:83]
    v_mfma_f32_4x4x4_16b_bf16 v[84:87], v[26:27], v[58:59], v[84:87]
    v_mfma_f32_4x4x4_16b_bf16 v[88:91], v[26:27], v[60:61], v[88:91]
    v_mfma_f32_4x4x4_16b_bf16 v[92:95], v[26:27], v[62:63], v[92:95]
    v_permlane32_swap_b32 v64, v66
    v_permlane32_swap_b32 v65, v67
    v_permlane32_swap_b32 v68, v70
    v_permlane32_swap_b32 v69, v71
    v_permlane32_swap_b32 v72, v74
    v_permlane32_swap_b32 v73, v75
    v_permlane32_swap_b32 v76, v78
    v_permlane32_swap_b32 v77, v79
    v_permlane32_swap_b32 v80, v82
    v_permlane32_swap_b32 v81, v83
    v_permlane32_swap_b32 v84, v86
    v_permlane32_swap_b32 v85, v87
    v_permlane32_swap_b32 v88, v90
    v_permlane32_swap_b32 v89, v91
    v_permlane32_swap_b32 v92, v94
    v_permlane32_swap_b32 v93, v95
    v_add_f32 v64, v64, v66
    v_add_f32 v65, v65, v67
    v_add_f32 v68, v68, v70
    v_add_f32 v69, v69, v71
    v_add_f32 v72, v72, v74
    v_add_f32 v73, v73, v75
    v_add_f32 v76, v76, v78
    v_add_f32 v77, v77, v79
    v_add_f32 v80, v80, v82
    v_add_f32 v81, v81, v83
    v_add_f32 v84, v84, v86
    v_add_f32 v85, v85, v87
    v_add_f32 v88, v88, v90
    v_add_f32 v89, v89, v91
    v_add_f32 v92, v92, v94
    v_add_f32 v93, v93, v95
    v_permlane16_swap_b32 v64, v65
    v_permlane16_swap_b32 v68, v69
    v_permlane16_swap_b32 v72, v73
    v_permlane16_swap_b32 v76, v77
    v_permlane16_swap_b32 v80, v81
    v_permlane16_swap_b32 v84, v85
    v_permlane16_swap_b32 v88, v89
    v_permlane16_swap_b32 v92, v93
    v_add_f32 v64, v64, v65
    v_add_f32 v68, v68, v69
    v_add_f32 v72, v72, v73
    v_add_f32 v76, v76, v77
    v_add_f32 v80, v80, v81
    v_add_f32 v84, v84, v85
    v_add_f32 v88, v88, v89
    v_add_f32 v92, v92, v93
    v_add_f32_dpp v64, v64, v64 row_ror:8 row_mask:0xf bank_mask:0xf
    v_add_f32_dpp v68, v68, v68 row_ror:8 row_mask:0xf bank_mask:0xf
    v_add_f32_dpp v72, v72, v72 row_ror:8 row_mask:0xf bank_mask:0xf
    v_add_f32_dpp v76, v76, v76 row_ror:8 row_mask:0xf bank_mask:0xf
    v_add_f32_dpp v80, v80, v80 row_ror:8 row_mask:0xf bank_mask:0xf
    v_add_f32_dpp v84, v84, v84 row_ror:8 row_mask:0xf bank_mask:0xf
    v_add_f32_dpp v88, v88, v88 row_ror:8 row_mask:0xf bank_mask:0xf
    v_add_f32_dpp v92, v92, v92 row_ror:8 row_mask:0xf bank_mask:0xf
    v_add_f32_dpp v64, v64, v64 row_ror:4 row_mask:0xf bank_mask:0xf
    v_add_f32_dpp v68, v68, v68 row_ror:4 row_mask:0xf bank_mask:0xf
    v_add_f32_dpp v72, v72, v72 row_ror:4 row_mask:0xf bank_mask:0xf
    v_add_f32_dpp v76, v76, v76 row_ror:4 row_mask:0xf bank_mask:0xf
    v_add_f32_dpp v80, v80, v80 row_ror:4 row_mask:0xf bank_mask:0xf
    v_add_f32_dpp v84, v84, v84 row_ror:4 row_mask:0xf bank_mask:0xf
    v_add_f32_dpp v88, v88, v88 row_ror:4 row_mask:0xf bank_mask:0xf
    v_add_f32_dpp v92, v92, v92 row_ror:4 row_mask:0xf bank_mask:0xf
    v_mov_b32_dpp v64, v80 quad_perm:[0,1,2,3] row_mask:0xf bank_mask:0xc
    v_mov_b32_dpp v68, v84 quad_perm:[0,1,2,3] row_mask:0xf bank_mask:0xc
    v_mov_b32_dpp v72, v88 quad_perm:[0,1,2,3] row_mask:0xf bank_mask:0xc
    v_mov_b32_dpp v76, v92 quad_perm:[0,1,2,3] row_mask:0xf bank_mask:0xc
    v_mov_b32 v48, v64
    v_mov_b32 v49, v68
    v_mov_b32 v50, v72
    v_mov_b32 v51, v76
    s_lshl_b32 s91, s78, 10
    v_add_u32 v4, s91, v3
    ds_write_b128 v4, v[48:51] offset:2048
    v_mov_b32 v5, 0
    ds_write_b32 v5, v5 offset:19200
    s_waitcnt lgkmcnt(0)
    s_add_u32 s76, s76, 1
    s_xor_b32 s77, s76, 0x5bd1e995
    s_barrier
    s_cmp_eq_u32 s78, 3
    s_cbranch_scc1 L_qphase
    s_waitcnt vmcnt(0)
    s_lshl_b32 s89, s97, 12
    s_add_u32 s89, s89, s83
    s_add_u32 s89, s89, 1703936
    buffer_load_dwordx4 a[16:19], v2, s[32:35], s89 offen offset:0 nt
    buffer_load_dwordx4 a[20:23], v2, s[32:35], s89 offen offset:1024 nt
    buffer_load_dwordx4 a[24:27], v2, s[32:35], s89 offen offset:2048 nt
    buffer_load_dwordx4 a[28:31], v2, s[32:35], s89 offen offset:3072 nt
    buffer_load_dwordx4 v[144:147], v3, s[36:39], s89 offen offset:0 nt
    buffer_load_dwordx4 v[148:151], v3, s[36:39], s89 offen offset:1024 nt
    buffer_load_dwordx4 v[152:155], v3, s[36:39], s89 offen offset:2048 nt
    buffer_load_dwordx4 v[156:159], v3, s[36:39], s89 offen offset:3072 nt
    s_cmp_lg_u32 s78, 0
    s_cbranch_scc1 L_nogate
    v_lshlrev_b32 v32, 16, v28
    v_and_b32 v33, 0xffff0000, v28
    v_lshlrev_b32 v34, 16, v40
    v_and_b32 v35, 0xffff0000, v40
    v_mul_f32 v32, v32, v34
    v_mul_f32 v33, v33, v35
    v_cvt_pk_bf16_f32 v32, v32, v33
    v_lshlrev_b32 v33, 16, v32
    v_and_b32 v32, 0xffff0000, v32
    v_add_f32 v32, v32, v33
    v_mov_b32 v36, v32
    v_lshlrev_b32 v32, 16, v29
    v_and_b32 v33, 0xffff0000, v29
    v_lshlrev_b32 v34, 16, v41
    v_and_b32 v35, 0xffff0000, v41
    v_mul_f32 v32, v32, v34
    v_mul_f32 v33, v33, v35
    v_cvt_pk_bf16_f32 v32, v32, v33
    v_lshlrev_b32 v33, 16, v32
    v_and_b32 v32, 0xffff0000, v32
    v_add_f32 v32, v32, v33
    v_add_f32 v36, v36, v32
    v_lshlrev_b32 v32, 16, v30
    v_and_b32 v33, 0xffff0000, v30
    v_lshlrev_b32 v34, 16, v42
    v_and_b32 v35, 0xffff0000, v42
    v_mul_f32 v32, v32, v34
    v_mul_f32 v33, v33, v35
    v_cvt_pk_bf16_f32 v32, v32, v33
    v_lshlrev_b32 v33, 16, v32
    v_and_b32 v32, 0xffff0000, v32
    v_add_f32 v32, v32, v33
    v_add_f32 v36, v36, v32
    v_lshlrev_b32 v32, 16, v31
    v_and_b32 v33, 0xffff0000, v31
    v_lshlrev_b32 v34, 16, v43
    v_and_b32 v35, 0xffff0000, v43
    v_mul_f32 v32, v32, v34
    v_mul_f32 v33, v33, v35
    v_cvt_pk_bf16_f32 v32, v32, v33
    v_lshlrev_b32 v33, 16, v32
    v_and_b32 v32, 0xffff0000, v32
    v_add_f32 v32, v32, v33
    v_add_f32 v36, v36, v32
    s_nop 1
    v_add_f32_dpp v36, v36, v36 quad_perm:[1,0,3,2] row_mask:0xf bank_mask:0xf
    s_nop 1
    v_add_f32_dpp v36, v36, v36 quad_perm:[2,3,0,1] row_mask:0xf bank_mask:0xf
    s_nop 1
    v_add_f32_dpp v36, v36, v36 row_ror:4 row_mask:0xf bank_mask:0xf
    s_nop 1
    v_add_f32_dpp v36, v36, v36 row_ror:8 row_mask:0xf bank_mask:0xf
    v_mov_b32 v37, v36
    s_nop 1
    v_permlane16_swap_b32 v36, v37
    v_add_f32 v36, v36, v37
    v_mov_b32 v37, v36
    s_nop 1
    v_permlane32_swap_b32 v36, v37
    v_add_f32 v36, v36, v37
    v_cvt_pk_bf16_f32 v36, v36, v36
    v_lshlrev_b32 v36, 16, v36
    v_mul_f32 v36, 0xbfb8aa3b, v36
    v_exp_f32 v36, v36
    s_nop 0
    v_add_f32 v36, 1.0, v36
    v_rcp_f32 v36, v36
    s_nop 0
    v_cvt_pk_bf16_f32 v36, v36, v36
    v_lshlrev_b32 v36, 16, v36
    v_sub_f32 v37, 1.0, v36
    v_cvt_pk_bf16_f32 v37, v37, v37
    v_lshlrev_b32 v37, 16, v37
    v_readfirstlane_b32 s95, v36
    v_readfirstlane_b32 s96, v37
L_nogate:
    s_waitcnt vmcnt(0)
    s_lshl_b32 s89, s97, 12
    s_add_u32 s89, s89, s83
    s_add_u32 s89, s89, 1835008
    buffer_load_dwordx4 a[32:35], v2, s[32:35], s89 offen offset:0 nt
    buffer_load_dwordx4 a[36:39], v2, s[32:35], s89 offen offset:1024 nt
    buffer_load_dwordx4 a[40:43], v2, s[32:35], s89 offen offset:2048 nt
    buffer_load_dwordx4 a[44:47], v2, s[32:35], s89 offen offset:3072 nt
    buffer_load_dwordx4 v[160:163], v3, s[36:39], s89 offen offset:0 nt
    buffer_load_dwordx4 v[164:167], v3, s[36:39], s89 offen offset:1024 nt
    buffer_load_dwordx4 v[168:171], v3, s[36:39], s89 offen offset:2048 nt
    buffer_load_dwordx4 v[172:175], v3, s[36:39], s89 offen offset:3072 nt
    s_waitcnt vmcnt(0)
    s_lshl_b32 s89, s97, 12
    s_add_u32 s89, s89, s83
    s_add_u32 s89, s89, 1966080
    buffer_load_dwordx4 a[48:51], v2, s[32:35], s89 offen offset:0 nt
    buffer_load_dwordx4 a[52:55], v2, s[32:35], s89 offen offset:1024 nt
    buffer_load_dwordx4 a[56:59], v2, s[32:35], s89 offen offset:2048 nt
    buffer_load_dwordx4 a[60:63], v2, s[32:35], s89 offen offset:3072 nt
    buffer_load_dwordx4 v[176:179], v3, s[36:39], s89 offen offset:0 nt
    buffer_load_dwordx4 v[180:183], v3, s[36:39], s89 offen offset:1024 nt
    buffer_load_dwordx4 v[184:187], v3, s[36:39], s89 offen offset:2048 nt
    buffer_load_dwordx4 v[188:191], v3, s[36:39], s89 offen offset:3072 nt
    s_waitcnt vmcnt(0)
    s_add_u32 s89, s97, 0
    s_lshl_b32 s89, s89, 12
    s_add_u32 s89, s89, s83
    buffer_load_dwordx4 a[64:67], v2, s[40:43], s89 offen offset:0 nt
    buffer_load_dwordx4 a[68:71], v2, s[40:43], s89 offen offset:1024 nt
    buffer_load_dwordx4 a[72:75], v2, s[40:43], s89 offen offset:2048 nt
    buffer_load_dwordx4 a[76:79], v2, s[40:43], s89 offen offset:3072 nt
    buffer_load_dwordx4 v[112:115], v3, s[44:47], s89 offen offset:0 nt
    buffer_load_dwordx4 v[116:119], v3, s[44:47], s89 offen offset:1024 nt
    buffer_load_dwordx4 v[120:123], v3, s[44:47], s89 offen offset:2048 nt
    buffer_load_dwordx4 v[124:127], v3, s[44:47], s89 offen offset:3072 nt
    s_waitcnt vmcnt(0)
    s_add_u32 s89, s97, 32
    s_lshl_b32 s89, s89, 12
    s_add_u32 s89, s89, s83
    buffer_load_dwordx4 a[80:83], v2, s[40:43], s89 offen offset:0 nt
    buffer_load_dwordx4 a[84:87], v2, s[40:43], s89 offen offset:1024 nt
    buffer_load_dwordx4 a[88:91], v2, s[40:43], s89 offen offset:2048 nt
    buffer_load_dwordx4 a[92:95], v2, s[40:43], s89 offen offset:3072 nt
    buffer_load_dwordx4 v[96:99], v3, s[44:47], s89 offen offset:0 nt
    buffer_load_dwordx4 v[100:103], v3, s[44:47], s89 offen offset:1024 nt
    buffer_load_dwordx4 v[104:107], v3, s[44:47], s89 offen offset:2048 nt
    buffer_load_dwordx4 v[108:111], v3, s[44:47], s89 offen offset:3072 nt
    v_mov_b32 v5, 0
    s_mov_b32 s98, 1280000
L_qflag:
    ds_read_b32 v24, v5 offset:19200
    s_waitcnt lgkmcnt(0)
    v_readfirstlane_b32 s91, v24
    s_nop 3
    s_cmp_lg_u32 s91, 0
    s_cbranch_scc1 L_common
    s_sub_u32 s98, s98, 1
    s_cbranch_scc1 L_common
    s_sleep 1
    s_branch L_qflag
L_qphase:
    ds_read_b128 v[32:35], v3 offset:2048
    ds_read_b128 v[36:39], v3 offset:3072
    ds_read_b128 v[40:43], v3 offset:4096
    ds_read_b128 v[44:47], v3 offset:5120
    v_lshrrev_b32 v4, 4, v1
    v_lshlrev_b32 v5, 14, v4
    v_bfe_u32 v4, v1, 3, 1
    v_lshl_add_u32 v5, v4, 4, v5
    v_and_b32 v4, 3, v1
    v_lshl_add_u32 v5, v4, 5, v5
    s_lshr_b32 s92, s81, 2
    s_lshl_b32 s92, s92, 16
    s_lshl_b32 s93, s80, 11
    s_add_u32 s92, s92, s93
    s_lshl_b32 s93, s99, 7
    s_add_u32 s92, s92, s93
    s_add_u32 s92, s92, 65536
    v_mov_b32 v26, s76
    v_mov_b32 v27, s77
    s_waitcnt lgkmcnt(0)
    v_add_f32 v32, v32, v36
    v_add_f32 v40, v40, v44
    v_add_f32 v33, v33, v37
    v_add_f32 v41, v41, v45
    v_add_f32 v34, v34, v38
    v_add_f32 v42, v42, v46
    v_add_f32 v35, v35, v39
    v_add_f32 v43, v43, v47
    v_add_f32 v32, v32, v40
    v_add_f32 v33, v33, v41
    v_add_f32 v34, v34, v42
    v_add_f32 v35, v35, v43
    v_cvt_pk_bf16_f32 v24, v32, v33
    v_cvt_pk_bf16_f32 v25, v34, v35
    buffer_store_dwordx4 v[24:27], v5, s[48:51], s92 offen sc1
    v_and_b32 v4, 3, v1
    v_lshlrev_b32 v5, 9, v4
    v_lshrrev_b32 v4, 2, v1
    v_lshl_add_u32 v5, v4, 5, v5
    s_lshl_b32 s93, s82, 11
    s_add_u32 s93, s93, 65536
    s_add_u32 s94, s93, 0x10000
    s_mov_b32 s98, 20000
    s_mov_b32 s90, 0
    s_waitcnt vmcnt(0)
    s_lshl_b32 s89, s97, 12
    s_add_u32 s89, s89, s83
    s_add_u32 s89, s89, 1703936
    buffer_load_dwordx4 a[16:19], v2, s[32:35], s89 offen offset:0 nt
    buffer_load_dwordx4 a[20:23], v2, s[32:35], s89 offen offset:1024 nt
    buffer_load_dwordx4 a[24:27], v2, s[32:35], s89 offen offset:2048 nt
    buffer_load_dwordx4 a[28:31], v2, s[32:35], s89 offen offset:3072 nt
    buffer_load_dwordx4 v[144:147], v3, s[36:39], s89 offen offset:0 nt
    buffer_load_dwordx4 v[148:151], v3, s[36:39], s89 offen offset:1024 nt
    buffer_load_dwordx4 v[152:155], v3, s[36:39], s89 offen offset:2048 nt
    buffer_load_dwordx4 v[156:159], v3, s[36:39], s89 offen offset:3072 nt
    s_waitcnt vmcnt(0)
    s_lshl_b32 s89, s97, 12
    s_add_u32 s89, s89, s83
    s_add_u32 s89, s89, 1835008
    buffer_load_dwordx4 a[32:35], v2, s[32:35], s89 offen offset:0 nt
    buffer_load_dwordx4 a[36:39], v2, s[32:35], s89 offen offset:1024 nt
    buffer_load_dwordx4 a[40:43], v2, s[32:35], s89 offen offset:2048 nt
    buffer_load_dwordx4 a[44:47], v2, s[32:35], s89 offen offset:3072 nt
    buffer_load_dwordx4 v[160:163], v3, s[36:39], s89 offen offset:0 nt
    buffer_load_dwordx4 v[164:167], v3, s[36:39], s89 offen offset:1024 nt
    buffer_load_dwordx4 v[168:171], v3, s[36:39], s89 offen offset:2048 nt
    buffer_load_dwordx4 v[172:175], v3, s[36:39], s89 offen offset:3072 nt
    s_cmp_lg_u32 s90, 0
    s_cbranch_scc1 L_q4_2
    buffer_load_dwordx4 v[32:35], v5, s[48:51], s93 offen sc1
    buffer_load_dwordx4 v[36:39], v5, s[48:51], s93 offen offset:16 sc1
    buffer_load_dwordx4 v[40:43], v5, s[48:51], s94 offen sc1
    buffer_load_dwordx4 v[44:47], v5, s[48:51], s94 offen offset:16 sc1
L_q4_2:
    s_waitcnt vmcnt(0)
    s_cmp_lg_u32 s90, 0
    s_cbranch_scc1 L_q3_3
    v_xor_b32 v48, s76, v34
    v_xor_b32 v49, s77, v35
    v_xor_b32 v50, s76, v38
    v_xor_b32 v51, s77, v39
    v_xor_b32 v52, s76, v42
    v_xor_b32 v53, s77, v43
    v_xor_b32 v54, s76, v46
    v_xor_b32 v55, s77, v47
    v_or3_b32 v48, v48, v49, v50
    v_or3_b32 v51, v51, v52, v53
    v_or3_b32 v48, v48, v54, v55
    v_or_b32 v48, v48, v51
    v_cmp_ne_u32 vcc, 0, v48
    s_nop 3
    s_cbranch_vccnz L_q3_3
    ds_write_b64 v3, v[32:33] offset:0
    ds_write_b64 v3, v[36:37] offset:8
    ds_write_b64 v3, v[40:41] offset:1024
    ds_write_b64 v3, v[44:45] offset:1032
    v_mov_b32 v24, 0
    v_mov_b32 v25, 1
    s_waitcnt lgkmcnt(0)
    ds_write_b32 v24, v25 offset:19200
    s_mov_b32 s90, 1
L_q3_3:
    s_lshl_b32 s89, s97, 12
    s_add_u32 s89, s89, s83
    s_add_u32 s89, s89, 1966080
    buffer_load_dwordx4 a[48:51], v2, s[32:35], s89 offen offset:0 nt
    buffer_load_dwordx4 a[52:55], v2, s[32:35], s89 offen offset:1024 nt
    buffer_load_dwordx4 a[56:59], v2, s[32:35], s89 offen offset:2048 nt
    buffer_load_dwordx4 a[60:63], v2, s[32:35], s89 offen offset:3072 nt
    buffer_load_dwordx4 v[176:179], v3, s[36:39], s89 offen offset:0 nt
    buffer_load_dwordx4 v[180:183], v3, s[36:39], s89 offen offset:1024 nt
    buffer_load_dwordx4 v[184:187], v3, s[36:39], s89 offen offset:2048 nt
    buffer_load_dwordx4 v[188:191], v3, s[36:39], s89 offen offset:3072 nt
    s_cmp_lg_u32 s90, 0
    s_cbranch_scc1 L_q4_3
    buffer_load_dwordx4 v[32:35], v5, s[48:51], s93 offen sc1
    buffer_load_dwordx4 v[36:39], v5, s[48:51], s93 offen offset:16 sc1
    buffer_load_dwordx4 v[40:43], v5, s[48:51], s94 offen sc1
    buffer_load_dwordx4 v[44:47], v5, s[48:51], s94 offen offset:16 sc1
L_q4_3:
    s_waitcnt vmcnt(0)
    s_cmp_lg_u32 s90, 0
    s_cbranch_scc1 L_q3_4
    v_xor_b32 v48, s76, v34
    v_xor_b32 v49, s77, v35
    v_xor_b32 v50, s76, v38
    v_xor_b32 v51, s77, v39
    v_xor_b32 v52, s76, v42
    v_xor_b32 v53, s77, v43
    v_xor_b32 v54, s76, v46
    v_xor_b32 v55, s77, v47
    v_or3_b32 v48, v48, v49, v50
    v_or3_b32 v51, v51, v52, v53
    v_or3_b32 v48, v48, v54, v55
    v_or_b32 v48, v48, v51
    v_cmp_ne_u32 vcc, 0, v48
    s_nop 3
    s_cbranch_vccnz L_q3_4
    ds_write_b64 v3, v[32:33] offset:0
    ds_write_b64 v3, v[36:37] offset:8
    ds_write_b64 v3, v[40:41] offset:1024
    ds_write_b64 v3, v[44:45] offset:1032
    v_mov_b32 v24, 0
    v_mov_b32 v25, 1
    s_waitcnt lgkmcnt(0)
    ds_write_b32 v24, v25 offset:19200
    s_mov_b32 s90, 1
L_q3_4:
    s_add_u32 s89, s97, 0
    s_lshl_b32 s89, s89, 12
    s_add_u32 s89, s89, s83
    buffer_load_dwordx4 a[64:67], v2, s[40:43], s89 offen offset:0 nt
    buffer_load_dwordx4 a[68:71], v2, s[40:43], s89 offen offset:1024 nt
    buffer_load_dwordx4 a[72:75], v2, s[40:43], s89 offen offset:2048 nt
    buffer_load_dwordx4 a[76:79], v2, s[40:43], s89 offen offset:3072 nt
    buffer_load_dwordx4 v[112:115], v3, s[44:47], s89 offen offset:0 nt
    buffer_load_dwordx4 v[116:119], v3, s[44:47], s89 offen offset:1024 nt
    buffer_load_dwordx4 v[120:123], v3, s[44:47], s89 offen offset:2048 nt
    buffer_load_dwordx4 v[124:127], v3, s[44:47], s89 offen offset:3072 nt
    s_cmp_lg_u32 s90, 0
    s_cbranch_scc1 L_q4_4
    buffer_load_dwordx4 v[32:35], v5, s[48:51], s93 offen sc1
    buffer_load_dwordx4 v[36:39], v5, s[48:51], s93 offen offset:16 sc1
    buffer_load_dwordx4 v[40:43], v5, s[48:51], s94 offen sc1
    buffer_load_dwordx4 v[44:47], v5, s[48:51], s94 offen offset:16 sc1
L_q4_4:
    s_waitcnt vmcnt(0)
    s_cmp_lg_u32 s90, 0
    s_cbranch_scc1 L_q3_5
    v_xor_b32 v48, s76, v34
    v_xor_b32 v49, s77, v35
    v_xor_b32 v50, s76, v38
    v_xor_b32 v51, s77, v39
    v_xor_b32 v52, s76, v42
    v_xor_b32 v53, s77, v43
    v_xor_b32 v54, s76, v46
    v_xor_b32 v55, s77, v47
    v_or3_b32 v48, v48, v49, v50
    v_or3_b32 v51, v51, v52, v53
    v_or3_b32 v48, v48, v54, v55
    v_or_b32 v48, v48, v51
    v_cmp_ne_u32 vcc, 0, v48
    s_nop 3
    s_cbranch_vccnz L_q3_5
    ds_write_b64 v3, v[32:33] offset:0
    ds_write_b64 v3, v[36:37] offset:8
    ds_write_b64 v3, v[40:41] offset:1024
    ds_write_b64 v3, v[44:45] offset:1032
    v_mov_b32 v24, 0
    v_mov_b32 v25, 1
    s_waitcnt lgkmcnt(0)
    ds_write_b32 v24, v25 offset:19200
    s_mov_b32 s90, 1
L_q3_5:
    s_add_u32 s89, s97, 32
    s_lshl_b32 s89, s89, 12
    s_add_u32 s89, s89, s83
    buffer_load_dwordx4 a[80:83], v2, s[40:43], s89 offen offset:0 nt
    buffer_load_dwordx4 a[84:87], v2, s[40:43], s89 offen offset:1024 nt
    buffer_load_dwordx4 a[88:91], v2, s[40:43], s89 offen offset:2048 nt
    buffer_load_dwordx4 a[92:95], v2, s[40:43], s89 offen offset:3072 nt
    buffer_load_dwordx4 v[96:99], v3, s[44:47], s89 offen offset:0 nt
    buffer_load_dwordx4 v[100:103], v3, s[44:47], s89 offen offset:1024 nt
    buffer_load_dwordx4 v[104:107], v3, s[44:47], s89 offen offset:2048 nt
    buffer_load_dwordx4 v[108:111], v3, s[44:47], s89 offen offset:3072 nt
    s_cmp_lg_u32 s90, 0
    s_cbranch_scc1 L_q4_5
    buffer_load_dwordx4 v[32:35], v5, s[48:51], s93 offen sc1
    buffer_load_dwordx4 v[36:39], v5, s[48:51], s93 offen offset:16 sc1
    buffer_load_dwordx4 v[40:43], v5, s[48:51], s94 offen sc1
    buffer_load_dwordx4 v[44:47], v5, s[48:51], s94 offen offset:16 sc1
L_q4_5:
    s_cmp_lg_u32 s90, 0
    s_cbranch_scc1 L_common
L_q_poll:
    s_waitcnt vmcnt(0)
    v_xor_b32 v48, s76, v34
    v_xor_b32 v49, s77, v35
    v_xor_b32 v50, s76, v38
    v_xor_b32 v51, s77, v39
    v_xor_b32 v52, s76, v42
    v_xor_b32 v53, s77, v43
    v_xor_b32 v54, s76, v46
    v_xor_b32 v55, s77, v47
    v_or3_b32 v48, v48, v49, v50
    v_or3_b32 v51, v51, v52, v53
    v_or3_b32 v48, v48, v54, v55
    v_or_b32 v48, v48, v51
    v_cmp_ne_u32 vcc, 0, v48
    s_nop 3
    s_cbranch_vccnz L_q_retry
L_q_done:
    ds_write_b64 v3, v[32:33] offset:0
    ds_write_b64 v3, v[36:37] offset:8
    ds_write_b64 v3, v[40:41] offset:1024
    ds_write_b64 v3, v[44:45] offset:1032
    v_mov_b32 v24, 0
    v_mov_b32 v25, 1
    s_waitcnt lgkmcnt(0)
    ds_write_b32 v24, v25 offset:19200
    s_mov_b32 s90, 1
    s_branch L_common
L_q_retry:
    s_sub_u32 s98, s98, 1
    s_cbranch_scc1 L_q_done
    buffer_load_dwordx4 v[32:35], v5, s[48:51], s93 offen sc1
    buffer_load_dwordx4 v[36:39], v5, s[48:51], s93 offen offset:16 sc1
    buffer_load_dwordx4 v[40:43], v5, s[48:51], s94 offen sc1
    buffer_load_dwordx4 v[44:47], v5, s[48:51], s94 offen offset:16 sc1
    s_branch L_q_poll
L_common:
    ds_read_b128 v[8:11], v3 offset:0
    ds_read_b128 v[12:15], v3 offset:1024
    v_lshrrev_b32 v24, 4, v1
    v_lshlrev_b32 v28, 9, v24
    v_and_b32 v24, 15, v1
    v_lshl_add_u32 v28, v24, 5, v28
    s_lshl_b32 s91, s78, 11
    v_add_u32 v28, s91, v28
    v_and_b32 v24, 3, v1
    v_lshlrev_b32 v29, 3, v24
    s_lshl_b32 s91, s78, 5
    v_add_u32 v29, s91, v29
    s_lshl_b32 s91, s78, 9
    v_lshlrev_b32 v30, 3, v1
    v_add_u32 v30, s91, v30
    s_lshl_b32 s91, s78, 3
    v_mov_b32 v31, s91
    s_lshl_b32 s91, s78, 8
    v_lshlrev_b32 v4, 2, v1
    v_add_u32 v4, s91, v4
    v_lshrrev_b32 v24, 3, v1
    v_lshlrev_b32 v5, 5, v24
    v_and_b32 v25, 7, v1
    v_lshlrev_b32 v6, 12, v25
    v_lshl_add_u32 v6, v24, 4, v6
    v_lshlrev_b32 v0, 14, v24
    v_lshl_add_u32 v0, v25, 4, v0
    v_lshlrev_b32 v7, 1, v1
    v_cmp_gt_u32 vcc, 8, v1
    v_bfrev_b32 v24, 2
    s_nop 0
    v_cndmask_b32 v7, v24, v7, vcc
    s_waitcnt lgkmcnt(0)
    s_waitcnt vmcnt(40)
    v_mfma_f32_16x16x32_bf16 v[32:35], a[0:3], v[8:11], 0
    v_mfma_f32_16x16x32_bf16 v[36:39], a[4:7], v[8:11], 0
    v_mfma_f32_16x16x32_bf16 v[40:43], a[8:11], v[8:11], 0
    v_mfma_f32_16x16x32_bf16 v[44:47], a[12:15], v[8:11], 0
    v_perm_b32 v48, v132, v128, s85
    v_perm_b32 v49, v140, v136, s85
    v_perm_b32 v50, v132, v128, s86
    v_perm_b32 v51, v140, v136, s86
    v_perm_b32 v52, v133, v129, s85
    v_perm_b32 v53, v141, v137, s85
    v_perm_b32 v54, v133, v129, s86
    v_perm_b32 v55, v141, v137, s86
    v_perm_b32 v56, v134, v130, s85
    v_perm_b32 v57, v142, v138, s85
    v_perm_b32 v58, v134, v130, s86
    v_perm_b32 v59, v142, v138, s86
    v_perm_b32 v60, v135, v131, s85
    v_perm_b32 v61, v143, v139, s85
    v_perm_b32 v62, v135, v131, s86
    v_perm_b32 v63, v143, v139, s86
    v_mov_b32_dpp v32, v33 quad_perm:[0,1,2,3] row_mask:0xf bank_mask:0x2
    v_mov_b32_dpp v36, v37 quad_perm:[0,1,2,3] row_mask:0xf bank_mask:0x2
    v_mov_b32_dpp v40, v41 quad_perm:[0,1,2,3] row_mask:0xf bank_mask:0x2
    v_mov_b32_dpp v44, v45 quad_perm:[0,1,2,3] row_mask:0xf bank_mask:0x2
    v_mov_b32_dpp v32, v34 quad_perm:[0,1,2,3] row_mask:0xf bank_mask:0x4
    v_mov_b32_dpp v36, v38 quad_perm:[0,1,2,3] row_mask:0xf bank_mask:0x4
    v_mov_b32_dpp v40, v42 quad_perm:[0,1,2,3] row_mask:0xf bank_mask:0x4
    v_mov_b32_dpp v44, v46 quad_perm:[0,1,2,3] row_mask:0xf bank_mask:0x4
    v_mov_b32_dpp v32, v35 quad_perm:[0,1,2,3] row_mask:0xf bank_mask:0x8
    v_mov_b32_dpp v36, v39 quad_perm:[0,1,2,3] row_mask:0xf bank_mask:0x8
    v_mov_b32_dpp v40, v43 quad_perm:[0,1,2,3] row_mask:0xf bank_mask:0x8
    v_mov_b32_dpp v44, v47 quad_perm:[0,1,2,3] row_mask:0xf bank_mask:0x8
    v_add_f32_dpp v32, v32, v32 row_ror:8 row_mask:0xf bank_mask:0xf
    v_add_f32_dpp v36, v36, v36 row_ror:8 row_mask:0xf bank_mask:0xf
    v_add_f32_dpp v40, v40, v40 row_ror:8 row_mask:0xf bank_mask:0xf
    v_add_f32_dpp v44, v44, v44 row_ror:8 row_mask:0xf bank_mask:0xf
    v_add_f32_dpp v32, v32, v32 row_ror:4 row_mask:0xf bank_mask:0xf
    v_add_f32_dpp v36, v36, v36 row_ror:4 row_mask:0xf bank_mask:0xf
    v_add_f32_dpp v40, v40, v40 row_ror:4 row_mask:0xf bank_mask:0xf
    v_add_f32_dpp v44, v44, v44 row_ror:4 row_mask:0xf bank_mask:0xf
    v_cvt_pk_bf16_f32 v24, v32, v36
    v_cvt_pk_bf16_f32 v25, v40, v44
    v_lshlrev_b32 v32, 16, v24
    v_and_b32 v36, 0xffff0000, v24
    v_lshlrev_b32 v40, 16, v25
    v_and_b32 v44, 0xffff0000, v25
    v_mul_f32 v32, 0x3db504f3, v32
    v_mul_f32 v36, 0x3db504f3, v36
    v_mul_f32 v40, 0x3db504f3, v40
    v_mul_f32 v44, 0x3db504f3, v44
    v_cvt_pk_bf16_f32 v24, v32, v36
    v_cvt_pk_bf16_f32 v25, v40, v44
    v_lshlrev_b32 v32, 16, v24
    v_and_b32 v36, 0xffff0000, v24
    v_lshlrev_b32 v40, 16, v25
    v_and_b32 v44, 0xffff0000, v25
    v_max3_f32 v26, v32, v36, v40
    v_max_f32 v26, v26, v44
    v_mov_b32 v27, v26
    s_nop 1
    v_permlane32_swap_b32 v26, v27
    v_max_f32 v26, v26, v27
    v_mov_b32 v27, v26
    s_nop 1
    v_permlane16_swap_b32 v26, v27
    v_max_f32 v16, v26, v27
    v_mul_f32 v19, s84, v16
    v_fma_f32 v32, v32, s84, -v19
    v_fma_f32 v36, v36, s84, -v19
    v_fma_f32 v40, v40, s84, -v19
    v_fma_f32 v44, v44, s84, -v19
    v_exp_f32 v32, v32
    v_exp_f32 v36, v36
    v_exp_f32 v40, v40
    v_exp_f32 v44, v44
    v_cvt_pk_bf16_f32 v22, v32, v36
    v_cvt_pk_bf16_f32 v23, v40, v44
    v_add_f32 v24, v32, v36
    v_add_f32 v25, v40, v44
    v_add_f32 v24, v24, v25
    v_mov_b32 v17, v24
    v_mfma_f32_4x4x4_16b_bf16 v[64:67], v[22:23], v[48:49], 0
    v_mfma_f32_4x4x4_16b_bf16 v[68:71], v[22:23], v[50:51], 0
    v_mfma_f32_4x4x4_16b_bf16 v[72:75], v[22:23], v[52:53], 0
    v_mfma_f32_4x4x4_16b_bf16 v[76:79], v[22:23], v[54:55], 0
    v_mfma_f32_4x4x4_16b_bf16 v[80:83], v[22:23], v[56:57], 0
    v_mfma_f32_4x4x4_16b_bf16 v[84:87], v[22:23], v[58:59], 0
    v_mfma_f32_4x4x4_16b_bf16 v[88:91], v[22:23], v[60:61], 0
    v_mfma_f32_4x4x4_16b_bf16 v[92:95], v[22:23], v[62:63], 0
    s_waitcnt vmcnt(32)
    v_mfma_f32_16x16x32_bf16 v[32:35], a[16:19], v[8:11], 0
    v_mfma_f32_16x16x32_bf16 v[36:39], a[20:23], v[8:11], 0
    v_mfma_f32_16x16x32_bf16 v[40:43], a[24:27], v[8:11], 0
    v_mfma_f32_16x16x32_bf16 v[44:47], a[28:31], v[8:11], 0
    v_perm_b32 v48, v148, v144, s85
    v_perm_b32 v49, v156, v152, s85
    v_perm_b32 v50, v148, v144, s86
    v_perm_b32 v51, v156, v152, s86
    v_perm_b32 v52, v149, v145, s85
    v_perm_b32 v53, v157, v153, s85
    v_perm_b32 v54, v149, v145, s86
    v_perm_b32 v55, v157, v153, s86
    v_perm_b32 v56, v150, v146, s85
    v_perm_b32 v57, v158, v154, s85
    v_perm_b32 v58, v150, v146, s86
    v_perm_b32 v59, v158, v154, s86
    v_perm_b32 v60, v151, v147, s85
    v_perm_b32 v61, v159, v155, s85
    v_perm_b32 v62, v151, v147, s86
    v_perm_b32 v63, v159, v155, s86
    v_mov_b32_dpp v32, v33 quad_perm:[0,1,2,3] row_mask:0xf bank_mask:0x2
    v_mov_b32_dpp v36, v37 quad_perm:[0,1,2,3] row_mask:0xf bank_mask:0x2
    v_mov_b32_dpp v40, v41 quad_perm:[0,1,2,3] row_mask:0xf bank_mask:0x2
    v_mov_b32_dpp v44, v45 quad_perm:[0,1,2,3] row_mask:0xf bank_mask:0x2
    v_mov_b32_dpp v32, v34 quad_perm:[0,1,2,3] row_mask:0xf bank_mask:0x4
    v_mov_b32_dpp v36, v38 quad_perm:[0,1,2,3] row_mask:0xf bank_mask:0x4
    v_mov_b32_dpp v40, v42 quad_perm:[0,1,2,3] row_mask:0xf bank_mask:0x4
    v_mov_b32_dpp v44, v46 quad_perm:[0,1,2,3] row_mask:0xf bank_mask:0x4
    v_mov_b32_dpp v32, v35 quad_perm:[0,1,2,3] row_mask:0xf bank_mask:0x8
    v_mov_b32_dpp v36, v39 quad_perm:[0,1,2,3] row_mask:0xf bank_mask:0x8
    v_mov_b32_dpp v40, v43 quad_perm:[0,1,2,3] row_mask:0xf bank_mask:0x8
    v_mov_b32_dpp v44, v47 quad_perm:[0,1,2,3] row_mask:0xf bank_mask:0x8
    v_add_f32_dpp v32, v32, v32 row_ror:8 row_mask:0xf bank_mask:0xf
    v_add_f32_dpp v36, v36, v36 row_ror:8 row_mask:0xf bank_mask:0xf
    v_add_f32_dpp v40, v40, v40 row_ror:8 row_mask:0xf bank_mask:0xf
    v_add_f32_dpp v44, v44, v44 row_ror:8 row_mask:0xf bank_mask:0xf
    v_add_f32_dpp v32, v32, v32 row_ror:4 row_mask:0xf bank_mask:0xf
    v_add_f32_dpp v36, v36, v36 row_ror:4 row_mask:0xf bank_mask:0xf
    v_add_f32_dpp v40, v40, v40 row_ror:4 row_mask:0xf bank_mask:0xf
    v_add_f32_dpp v44, v44, v44 row_ror:4 row_mask:0xf bank_mask:0xf
    v_cvt_pk_bf16_f32 v24, v32, v36
    v_cvt_pk_bf16_f32 v25, v40, v44
    v_lshlrev_b32 v32, 16, v24
    v_and_b32 v36, 0xffff0000, v24
    v_lshlrev_b32 v40, 16, v25
    v_and_b32 v44, 0xffff0000, v25
    v_mul_f32 v32, 0x3db504f3, v32
    v_mul_f32 v36, 0x3db504f3, v36
    v_mul_f32 v40, 0x3db504f3, v40
    v_mul_f32 v44, 0x3db504f3, v44
    v_cvt_pk_bf16_f32 v24, v32, v36
    v_cvt_pk_bf16_f32 v25, v40, v44
    v_lshlrev_b32 v32, 16, v24
    v_and_b32 v36, 0xffff0000, v24
    v_lshlrev_b32 v40, 16, v25
    v_and_b32 v44, 0xffff0000, v25
    v_max3_f32 v26, v32, v36, v40
    v_max_f32 v26, v26, v44
    v_mov_b32 v27, v26
    s_nop 1
    v_permlane32_swap_b32 v26, v27
    v_max_f32 v26, v26, v27
    v_mov_b32 v27, v26
    s_nop 1
    v_permlane16_swap_b32 v26, v27
    v_max3_f32 v26, v26, v27, v16
    v_cmp_gt_f32 vcc, v26, v16
    v_mul_f32 v19, s84, v26
    v_fma_f32 v18, v16, s84, -v19
    v_mov_b32 v16, v26
    v_exp_f32 v18, v18
    v_fma_f32 v32, v32, s84, -v19
    v_fma_f32 v36, v36, s84, -v19
    v_fma_f32 v40, v40, s84, -v19
    v_fma_f32 v44, v44, s84, -v19
    v_exp_f32 v32, v32
    v_exp_f32 v36, v36
    v_exp_f32 v40, v40
    v_exp_f32 v44, v44
    s_cbranch_vccz L_keep1
    v_mul_f32_dpp v64, v18, v64 quad_perm:[0,0,0,0] row_mask:0xf bank_mask:0xf
    v_mul_f32_dpp v65, v18, v65 quad_perm:[1,1,1,1] row_mask:0xf bank_mask:0xf
    v_mul_f32_dpp v66, v18, v66 quad_perm:[2,2,2,2] row_mask:0xf bank_mask:0xf
    v_mul_f32_dpp v67, v18, v67 quad_perm:[3,3,3,3] row_mask:0xf bank_mask:0xf
    v_mul_f32_dpp v68, v18, v68 quad_perm:[0,0,0,0] row_mask:0xf bank_mask:0xf
    v_mul_f32_dpp v69, v18, v69 quad_perm:[1,1,1,1] row_mask:0xf bank_mask:0xf
    v_mul_f32_dpp v70, v18, v70 quad_perm:[2,2,2,2] row_mask:0xf bank_mask:0xf
    v_mul_f32_dpp v71, v18, v71 quad_perm:[3,3,3,3] row_mask:0xf bank_mask:0xf
    v_mul_f32_dpp v72, v18, v72 quad_perm:[0,0,0,0] row_mask:0xf bank_mask:0xf
    v_mul_f32_dpp v73, v18, v73 quad_perm:[1,1,1,1] row_mask:0xf bank_mask:0xf
    v_mul_f32_dpp v74, v18, v74 quad_perm:[2,2,2,2] row_mask:0xf bank_mask:0xf
    v_mul_f32_dpp v75, v18, v75 quad_perm:[3,3,3,3] row_mask:0xf bank_mask:0xf
    v_mul_f32_dpp v76, v18, v76 quad_perm:[0,0,0,0] row_mask:0xf bank_mask:0xf
    v_mul_f32_dpp v77, v18, v77 quad_perm:[1,1,1,1] row_mask:0xf bank_mask:0xf
    v_mul_f32_dpp v78, v18, v78 quad_perm:[2,2,2,2] row_mask:0xf bank_mask:0xf
    v_mul_f32_dpp v79, v18, v79 quad_perm:[3,3,3,3] row_mask:0xf bank_mask:0xf
    v_mul_f32_dpp v80, v18, v80 quad_perm:[0,0,0,0] row_mask:0xf bank_mask:0xf
    v_mul_f32_dpp v81, v18, v81 quad_perm:[1,1,1,1] row_mask:0xf bank_mask:0xf
    v_mul_f32_dpp v82, v18, v82 quad_perm:[2,2,2,2] row_mask:0xf bank_mask:0xf
    v_mul_f32_dpp v83, v18, v83 quad_perm:[3,3,3,3] row_mask:0xf bank_mask:0xf
    v_mul_f32_dpp v84, v18, v84 quad_perm:[0,0,0,0] row_mask:0xf bank_mask:0xf
    v_mul_f32_dpp v85, v18, v85 quad_perm:[1,1,1,1] row_mask:0xf bank_mask:0xf
    v_mul_f32_dpp v86, v18, v86 quad_perm:[2,2,2,2] row_mask:0xf bank_mask:0xf
    v_mul_f32_dpp v87, v18, v87 quad_perm:[3,3,3,3] row_mask:0xf bank_mask:0xf
    v_mul_f32_dpp v88, v18, v88 quad_perm:[0,0,0,0] row_mask:0xf bank_mask:0xf
    v_mul_f32_dpp v89, v18, v89 quad_perm:[1,1,1,1] row_mask:0xf bank_mask:0xf
    v_mul_f32_dpp v90, v18, v90 quad_perm:[2,2,2,2] row_mask:0xf bank_mask:0xf
    v_mul_f32_dpp v91, v18, v91 quad_perm:[3,3,3,3] row_mask:0xf bank_mask:0xf
    v_mul_f32_dpp v92, v18, v92 quad_perm:[0,0,0,0] row_mask:0xf bank_mask:0xf
    v_mul_f32_dpp v93, v18, v93 quad_perm:[1,1,1,1] row_mask:0xf bank_mask:0xf
    v_mul_f32_dpp v94, v18, v94 quad_perm:[2,2,2,2] row_mask:0xf bank_mask:0xf
    v_mul_f32_dpp v95, v18, v95 quad_perm:[3,3,3,3] row_mask:0xf bank_mask:0xf
L_keep1:
    v_cvt_pk_bf16_f32 v22, v32, v36
    v_cvt_pk_bf16_f32 v23, v40, v44
    v_add_f32 v24, v32, v36
    v_add_f32 v25, v40, v44
    v_add_f32 v24, v24, v25
    v_fma_f32 v17, v17, v18, v24
    v_mfma_f32_4x4x4_16b_bf16 v[64:67], v[22:23], v[48:49], v[64:67]
    v_mfma_f32_4x4x4_16b_bf16 v[68:71], v[22:23], v[50:51], v[68:71]
    v_mfma_f32_4x4x4_16b_bf16 v[72:75], v[22:23], v[52:53], v[72:75]
    v_mfma_f32_4x4x4_16b_bf16 v[76:79], v[22:23], v[54:55], v[76:79]
    v_mfma_f32_4x4x4_16b_bf16 v[80:83], v[22:23], v[56:57], v[80:83]
    v_mfma_f32_4x4x4_16b_bf16 v[84:87], v[22:23], v[58:59], v[84:87]
    v_mfma_f32_4x4x4_16b_bf16 v[88:91], v[22:23], v[60:61], v[88:91]
    v_mfma_f32_4x4x4_16b_bf16 v[92:95], v[22:23], v[62:63], v[92:95]
    s_waitcnt vmcnt(24)
    v_mfma_f32_16x16x32_bf16 v[32:35], a[32:35], v[8:11], 0
    v_mfma_f32_16x16x32_bf16 v[36:39], a[36:39], v[8:11], 0
    v_mfma_f32_16x16x32_bf16 v[40:43], a[40:43], v[8:11], 0
    v_mfma_f32_16x16x32_bf16 v[44:47], a[44:47], v[8:11], 0
    v_perm_b32 v48, v164, v160, s85
    v_perm_b32 v49, v172, v168, s85
    v_perm_b32 v50, v164, v160, s86
    v_perm_b32 v51, v172, v168, s86
    v_perm_b32 v52, v165, v161, s85
    v_perm_b32 v53, v173, v169, s85
    v_perm_b32 v54, v165, v161, s86
    v_perm_b32 v55, v173, v169, s86
    v_perm_b32 v56, v166, v162, s85
    v_perm_b32 v57, v174, v170, s85
    v_perm_b32 v58, v166, v162, s86
    v_perm_b32 v59, v174, v170, s86
    v_perm_b32 v60, v167, v163, s85
    v_perm_b32 v61, v175, v171, s85
    v_perm_b32 v62, v167, v163, s86
    v_perm_b32 v63, v175, v171, s86
    v_mov_b32_dpp v32, v33 quad_perm:[0,1,2,3] row_mask:0xf bank_mask:0x2
    v_mov_b32_dpp v36, v37 quad_perm:[0,1,2,3] row_mask:0xf bank_mask:0x2
    v_mov_b32_dpp v40, v41 quad_perm:[0,1,2,3] row_mask:0xf bank_mask:0x2
    v_mov_b32_dpp v44, v45 quad_perm:[0,1,2,3] row_mask:0xf bank_mask:0x2
    v_mov_b32_dpp v32, v34 quad_perm:[0,1,2,3] row_mask:0xf bank_mask:0x4
    v_mov_b32_dpp v36, v38 quad_perm:[0,1,2,3] row_mask:0xf bank_mask:0x4
    v_mov_b32_dpp v40, v42 quad_perm:[0,1,2,3] row_mask:0xf bank_mask:0x4
    v_mov_b32_dpp v44, v46 quad_perm:[0,1,2,3] row_mask:0xf bank_mask:0x4
    v_mov_b32_dpp v32, v35 quad_perm:[0,1,2,3] row_mask:0xf bank_mask:0x8
    v_mov_b32_dpp v36, v39 quad_perm:[0,1,2,3] row_mask:0xf bank_mask:0x8
    v_mov_b32_dpp v40, v43 quad_perm:[0,1,2,3] row_mask:0xf bank_mask:0x8
    v_mov_b32_dpp v44, v47 quad_perm:[0,1,2,3] row_mask:0xf bank_mask:0x8
    v_add_f32_dpp v32, v32, v32 row_ror:8 row_mask:0xf bank_mask:0xf
    v_add_f32_dpp v36, v36, v36 row_ror:8 row_mask:0xf bank_mask:0xf
    v_add_f32_dpp v40, v40, v40 row_ror:8 row_mask:0xf bank_mask:0xf
    v_add_f32_dpp v44, v44, v44 row_ror:8 row_mask:0xf bank_mask:0xf
    v_add_f32_dpp v32, v32, v32 row_ror:4 row_mask:0xf bank_mask:0xf
    v_add_f32_dpp v36, v36, v36 row_ror:4 row_mask:0xf bank_mask:0xf
    v_add_f32_dpp v40, v40, v40 row_ror:4 row_mask:0xf bank_mask:0xf
    v_add_f32_dpp v44, v44, v44 row_ror:4 row_mask:0xf bank_mask:0xf
    v_cvt_pk_bf16_f32 v24, v32, v36
    v_cvt_pk_bf16_f32 v25, v40, v44
    v_lshlrev_b32 v32, 16, v24
    v_and_b32 v36, 0xffff0000, v24
    v_lshlrev_b32 v40, 16, v25
    v_and_b32 v44, 0xffff0000, v25
    v_mul_f32 v32, 0x3db504f3, v32
    v_mul_f32 v36, 0x3db504f3, v36
    v_mul_f32 v40, 0x3db504f3, v40
    v_mul_f32 v44, 0x3db504f3, v44
    v_cvt_pk_bf16_f32 v24, v32, v36
    v_cvt_pk_bf16_f32 v25, v40, v44
    v_lshlrev_b32 v32, 16, v24
    v_and_b32 v36, 0xffff0000, v24
    v_lshlrev_b32 v40, 16, v25
    v_and_b32 v44, 0xffff0000, v25
    v_max3_f32 v26, v32, v36, v40
    v_max_f32 v26, v26, v44
    v_mov_b32 v27, v26
    s_nop 1
    v_permlane32_swap_b32 v26, v27
    v_max_f32 v26, v26, v27
    v_mov_b32 v27, v26
    s_nop 1
    v_permlane16_swap_b32 v26, v27
    v_max3_f32 v26, v26, v27, v16
    v_cmp_gt_f32 vcc, v26, v16
    v_mul_f32 v19, s84, v26
    v_fma_f32 v18, v16, s84, -v19
    v_mov_b32 v16, v26
    v_exp_f32 v18, v18
    v_fma_f32 v32, v32, s84, -v19
    v_fma_f32 v36, v36, s84, -v19
    v_fma_f32 v40, v40, s84, -v19
    v_fma_f32 v44, v44, s84, -v19
    v_exp_f32 v32, v32
    v_exp_f32 v36, v36
    v_exp_f32 v40, v40
    v_exp_f32 v44, v44
    s_cbranch_vccz L_keep2
    v_mul_f32_dpp v64, v18, v64 quad_perm:[0,0,0,0] row_mask:0xf bank_mask:0xf
    v_mul_f32_dpp v65, v18, v65 quad_perm:[1,1,1,1] row_mask:0xf bank_mask:0xf
    v_mul_f32_dpp v66, v18, v66 quad_perm:[2,2,2,2] row_mask:0xf bank_mask:0xf
    v_mul_f32_dpp v67, v18, v67 quad_perm:[3,3,3,3] row_mask:0xf bank_mask:0xf
    v_mul_f32_dpp v68, v18, v68 quad_perm:[0,0,0,0] row_mask:0xf bank_mask:0xf
    v_mul_f32_dpp v69, v18, v69 quad_perm:[1,1,1,1] row_mask:0xf bank_mask:0xf
    v_mul_f32_dpp v70, v18, v70 quad_perm:[2,2,2,2] row_mask:0xf bank_mask:0xf
    v_mul_f32_dpp v71, v18, v71 quad_perm:[3,3,3,3] row_mask:0xf bank_mask:0xf
    v_mul_f32_dpp v72, v18, v72 quad_perm:[0,0,0,0] row_mask:0xf bank_mask:0xf
    v_mul_f32_dpp v73, v18, v73 quad_perm:[1,1,1,1] row_mask:0xf bank_mask:0xf
    v_mul_f32_dpp v74, v18, v74 quad_perm:[2,2,2,2] row_mask:0xf bank_mask:0xf
    v_mul_f32_dpp v75, v18, v75 quad_perm:[3,3,3,3] row_mask:0xf bank_mask:0xf
    v_mul_f32_dpp v76, v18, v76 quad_perm:[0,0,0,0] row_mask:0xf bank_mask:0xf
    v_mul_f32_dpp v77, v18, v77 quad_perm:[1,1,1,1] row_mask:0xf bank_mask:0xf
    v_mul_f32_dpp v78, v18, v78 quad_perm:[2,2,2,2] row_mask:0xf bank_mask:0xf
    v_mul_f32_dpp v79, v18, v79 quad_perm:[3,3,3,3] row_mask:0xf bank_mask:0xf
    v_mul_f32_dpp v80, v18, v80 quad_perm:[0,0,0,0] row_mask:0xf bank_mask:0xf
    v_mul_f32_dpp v81, v18, v81 quad_perm:[1,1,1,1] row_mask:0xf bank_mask:0xf
    v_mul_f32_dpp v82, v18, v82 quad_perm:[2,2,2,2] row_mask:0xf bank_mask:0xf
    v_mul_f32_dpp v83, v18, v83 quad_perm:[3,3,3,3] row_mask:0xf bank_mask:0xf
    v_mul_f32_dpp v84, v18, v84 quad_perm:[0,0,0,0] row_mask:0xf bank_mask:0xf
    v_mul_f32_dpp v85, v18, v85 quad_perm:[1,1,1,1] row_mask:0xf bank_mask:0xf
    v_mul_f32_dpp v86, v18, v86 quad_perm:[2,2,2,2] row_mask:0xf bank_mask:0xf
    v_mul_f32_dpp v87, v18, v87 quad_perm:[3,3,3,3] row_mask:0xf bank_mask:0xf
    v_mul_f32_dpp v88, v18, v88 quad_perm:[0,0,0,0] row_mask:0xf bank_mask:0xf
    v_mul_f32_dpp v89, v18, v89 quad_perm:[1,1,1,1] row_mask:0xf bank_mask:0xf
    v_mul_f32_dpp v90, v18, v90 quad_perm:[2,2,2,2] row_mask:0xf bank_mask:0xf
    v_mul_f32_dpp v91, v18, v91 quad_perm:[3,3,3,3] row_mask:0xf bank_mask:0xf
    v_mul_f32_dpp v92, v18, v92 quad_perm:[0,0,0,0] row_mask:0xf bank_mask:0xf
    v_mul_f32_dpp v93, v18, v93 quad_perm:[1,1,1,1] row_mask:0xf bank_mask:0xf
    v_mul_f32_dpp v94, v18, v94 quad_perm:[2,2,2,2] row_mask:0xf bank_mask:0xf
    v_mul_f32_dpp v95, v18, v95 quad_perm:[3,3,3,3] row_mask:0xf bank_mask:0xf
L_keep2:
    v_cvt_pk_bf16_f32 v22, v32, v36
    v_cvt_pk_bf16_f32 v23, v40, v44
    v_add_f32 v24, v32, v36
    v_add_f32 v25, v40, v44
    v_add_f32 v24, v24, v25
    v_fma_f32 v17, v17, v18, v24
    v_mfma_f32_4x4x4_16b_bf16 v[64:67], v[22:23], v[48:49], v[64:67]
    v_mfma_f32_4x4x4_16b_bf16 v[68:71], v[22:23], v[50:51], v[68:71]
    v_mfma_f32_4x4x4_16b_bf16 v[72:75], v[22:23], v[52:53], v[72:75]
    v_mfma_f32_4x4x4_16b_bf16 v[76:79], v[22:23], v[54:55], v[76:79]
    v_mfma_f32_4x4x4_16b_bf16 v[80:83], v[22:23], v[56:57], v[80:83]
    v_mfma_f32_4x4x4_16b_bf16 v[84:87], v[22:23], v[58:59], v[84:87]
    v_mfma_f32_4x4x4_16b_bf16 v[88:91], v[22:23], v[60:61], v[88:91]
    v_mfma_f32_4x4x4_16b_bf16 v[92:95], v[22:23], v[62:63], v[92:95]
    s_waitcnt vmcnt(0)
    s_add_u32 s89, s97, 64
    s_lshl_b32 s89, s89, 12
    s_add_u32 s89, s89, s83
    buffer_load_dwordx4 a[0:3], v2, s[40:43], s89 offen offset:0 nt
    buffer_load_dwordx4 a[4:7], v2, s[40:43], s89 offen offset:1024 nt
    buffer_load_dwordx4 a[8:11], v2, s[40:43], s89 offen offset:2048 nt
    buffer_load_dwordx4 a[12:15], v2, s[40:43], s89 offen offset:3072 nt
    buffer_load_dwordx4 v[128:131], v3, s[44:47], s89 offen offset:0 nt
    buffer_load_dwordx4 v[132:135], v3, s[44:47], s89 offen offset:1024 nt
    buffer_load_dwordx4 v[136:139], v3, s[44:47], s89 offen offset:2048 nt
    buffer_load_dwordx4 v[140:143], v3, s[44:47], s89 offen offset:3072 nt
    v_mfma_f32_16x16x32_bf16 v[32:35], a[48:51], v[8:11], 0
    v_mfma_f32_16x16x32_bf16 v[36:39], a[52:55], v[8:11], 0
    v_mfma_f32_16x16x32_bf16 v[40:43], a[56:59], v[8:11], 0
    v_mfma_f32_16x16x32_bf16 v[44:47], a[60:63], v[8:11], 0
    v_perm_b32 v48, v180, v176, s85
    v_perm_b32 v49, v188, v184, s85
    v_perm_b32 v50, v180, v176, s86
    v_perm_b32 v51, v188, v184, s86
    v_perm_b32 v52, v181, v177, s85
    v_perm_b32 v53, v189, v185, s85
    v_perm_b32 v54, v181, v177, s86
    v_perm_b32 v55, v189, v185, s86
    v_perm_b32 v56, v182, v178, s85
    v_perm_b32 v57, v190, v186, s85
    v_perm_b32 v58, v182, v178, s86
    v_perm_b32 v59, v190, v186, s86
    v_perm_b32 v60, v183, v179, s85
    v_perm_b32 v61, v191, v187, s85
    v_perm_b32 v62, v183, v179, s86
    v_perm_b32 v63, v191, v187, s86
    v_mov_b32_dpp v32, v33 quad_perm:[0,1,2,3] row_mask:0xf bank_mask:0x2
    v_mov_b32_dpp v36, v37 quad_perm:[0,1,2,3] row_mask:0xf bank_mask:0x2
    v_mov_b32_dpp v40, v41 quad_perm:[0,1,2,3] row_mask:0xf bank_mask:0x2
    v_mov_b32_dpp v44, v45 quad_perm:[0,1,2,3] row_mask:0xf bank_mask:0x2
    v_mov_b32_dpp v32, v34 quad_perm:[0,1,2,3] row_mask:0xf bank_mask:0x4
    v_mov_b32_dpp v36, v38 quad_perm:[0,1,2,3] row_mask:0xf bank_mask:0x4
    v_mov_b32_dpp v40, v42 quad_perm:[0,1,2,3] row_mask:0xf bank_mask:0x4
    v_mov_b32_dpp v44, v46 quad_perm:[0,1,2,3] row_mask:0xf bank_mask:0x4
    v_mov_b32_dpp v32, v35 quad_perm:[0,1,2,3] row_mask:0xf bank_mask:0x8
    v_mov_b32_dpp v36, v39 quad_perm:[0,1,2,3] row_mask:0xf bank_mask:0x8
    v_mov_b32_dpp v40, v43 quad_perm:[0,1,2,3] row_mask:0xf bank_mask:0x8
    v_mov_b32_dpp v44, v47 quad_perm:[0,1,2,3] row_mask:0xf bank_mask:0x8
    v_add_f32_dpp v32, v32, v32 row_ror:8 row_mask:0xf bank_mask:0xf
    v_add_f32_dpp v36, v36, v36 row_ror:8 row_mask:0xf bank_mask:0xf
    v_add_f32_dpp v40, v40, v40 row_ror:8 row_mask:0xf bank_mask:0xf
    v_add_f32_dpp v44, v44, v44 row_ror:8 row_mask:0xf bank_mask:0xf
    v_add_f32_dpp v32, v32, v32 row_ror:4 row_mask:0xf bank_mask:0xf
    v_add_f32_dpp v36, v36, v36 row_ror:4 row_mask:0xf bank_mask:0xf
    v_add_f32_dpp v40, v40, v40 row_ror:4 row_mask:0xf bank_mask:0xf
    v_add_f32_dpp v44, v44, v44 row_ror:4 row_mask:0xf bank_mask:0xf
    v_cvt_pk_bf16_f32 v24, v32, v36
    v_cvt_pk_bf16_f32 v25, v40, v44
    v_lshlrev_b32 v32, 16, v24
    v_and_b32 v36, 0xffff0000, v24
    v_lshlrev_b32 v40, 16, v25
    v_and_b32 v44, 0xffff0000, v25
    v_mul_f32 v32, 0x3db504f3, v32
    v_mul_f32 v36, 0x3db504f3, v36
    v_mul_f32 v40, 0x3db504f3, v40
    v_mul_f32 v44, 0x3db504f3, v44
    v_cvt_pk_bf16_f32 v24, v32, v36
    v_cvt_pk_bf16_f32 v25, v40, v44
    v_lshlrev_b32 v32, 16, v24
    v_and_b32 v36, 0xffff0000, v24
    v_lshlrev_b32 v40, 16, v25
    v_and_b32 v44, 0xffff0000, v25
    v_max3_f32 v26, v32, v36, v40
    v_max_f32 v26, v26, v44
    v_mov_b32 v27, v26
    s_nop 1
    v_permlane32_swap_b32 v26, v27
    v_max_f32 v26, v26, v27
    v_mov_b32 v27, v26
    s_nop 1
    v_permlane16_swap_b32 v26, v27
    v_max3_f32 v26, v26, v27, v16
    v_cmp_gt_f32 vcc, v26, v16
    v_mul_f32 v19, s84, v26
    v_fma_f32 v18, v16, s84, -v19
    v_mov_b32 v16, v26
    v_exp_f32 v18, v18
    v_fma_f32 v32, v32, s84, -v19
    v_fma_f32 v36, v36, s84, -v19
    v_fma_f32 v40, v40, s84, -v19
    v_fma_f32 v44, v44, s84, -v19
    v_exp_f32 v32, v32
    v_exp_f32 v36, v36
    v_exp_f32 v40, v40
    v_exp_f32 v44, v44
    s_cbranch_vccz L_keep3
    v_mul_f32_dpp v64, v18, v64 quad_perm:[0,0,0,0] row_mask:0xf bank_mask:0xf
    v_mul_f32_dpp v65, v18, v65 quad_perm:[1,1,1,1] row_mask:0xf bank_mask:0xf
    v_mul_f32_dpp v66, v18, v66 quad_perm:[2,2,2,2] row_mask:0xf bank_mask:0xf
    v_mul_f32_dpp v67, v18, v67 quad_perm:[3,3,3,3] row_mask:0xf bank_mask:0xf
    v_mul_f32_dpp v68, v18, v68 quad_perm:[0,0,0,0] row_mask:0xf bank_mask:0xf
    v_mul_f32_dpp v69, v18, v69 quad_perm:[1,1,1,1] row_mask:0xf bank_mask:0xf
    v_mul_f32_dpp v70, v18, v70 quad_perm:[2,2,2,2] row_mask:0xf bank_mask:0xf
    v_mul_f32_dpp v71, v18, v71 quad_perm:[3,3,3,3] row_mask:0xf bank_mask:0xf
    v_mul_f32_dpp v72, v18, v72 quad_perm:[0,0,0,0] row_mask:0xf bank_mask:0xf
    v_mul_f32_dpp v73, v18, v73 quad_perm:[1,1,1,1] row_mask:0xf bank_mask:0xf
    v_mul_f32_dpp v74, v18, v74 quad_perm:[2,2,2,2] row_mask:0xf bank_mask:0xf
    v_mul_f32_dpp v75, v18, v75 quad_perm:[3,3,3,3] row_mask:0xf bank_mask:0xf
    v_mul_f32_dpp v76, v18, v76 quad_perm:[0,0,0,0] row_mask:0xf bank_mask:0xf
    v_mul_f32_dpp v77, v18, v77 quad_perm:[1,1,1,1] row_mask:0xf bank_mask:0xf
    v_mul_f32_dpp v78, v18, v78 quad_perm:[2,2,2,2] row_mask:0xf bank_mask:0xf
    v_mul_f32_dpp v79, v18, v79 quad_perm:[3,3,3,3] row_mask:0xf bank_mask:0xf
    v_mul_f32_dpp v80, v18, v80 quad_perm:[0,0,0,0] row_mask:0xf bank_mask:0xf
    v_mul_f32_dpp v81, v18, v81 quad_perm:[1,1,1,1] row_mask:0xf bank_mask:0xf
    v_mul_f32_dpp v82, v18, v82 quad_perm:[2,2,2,2] row_mask:0xf bank_mask:0xf
    v_mul_f32_dpp v83, v18, v83 quad_perm:[3,3,3,3] row_mask:0xf bank_mask:0xf
    v_mul_f32_dpp v84, v18, v84 quad_perm:[0,0,0,0] row_mask:0xf bank_mask:0xf
    v_mul_f32_dpp v85, v18, v85 quad_perm:[1,1,1,1] row_mask:0xf bank_mask:0xf
    v_mul_f32_dpp v86, v18, v86 quad_perm:[2,2,2,2] row_mask:0xf bank_mask:0xf
    v_mul_f32_dpp v87, v18, v87 quad_perm:[3,3,3,3] row_mask:0xf bank_mask:0xf
    v_mul_f32_dpp v88, v18, v88 quad_perm:[0,0,0,0] row_mask:0xf bank_mask:0xf
    v_mul_f32_dpp v89, v18, v89 quad_perm:[1,1,1,1] row_mask:0xf bank_mask:0xf
    v_mul_f32_dpp v90, v18, v90 quad_perm:[2,2,2,2] row_mask:0xf bank_mask:0xf
    v_mul_f32_dpp v91, v18, v91 quad_perm:[3,3,3,3] row_mask:0xf bank_mask:0xf
    v_mul_f32_dpp v92, v18, v92 quad_perm:[0,0,0,0] row_mask:0xf bank_mask:0xf
    v_mul_f32_dpp v93, v18, v93 quad_perm:[1,1,1,1] row_mask:0xf bank_mask:0xf
    v_mul_f32_dpp v94, v18, v94 quad_perm:[2,2,2,2] row_mask:0xf bank_mask:0xf
    v_mul_f32_dpp v95, v18, v95 quad_perm:[3,3,3,3] row_mask:0xf bank_mask:0xf
L_keep3:
    v_cvt_pk_bf16_f32 v22, v32, v36
    v_cvt_pk_bf16_f32 v23, v40, v44
    v_add_f32 v24, v32, v36
    v_add_f32 v25, v40, v44
    v_add_f32 v24, v24, v25
    v_fma_f32 v17, v17, v18, v24
    v_mfma_f32_4x4x4_16b_bf16 v[64:67], v[22:23], v[48:49], v[64:67]
    v_mfma_f32_4x4x4_16b_bf16 v[68:71], v[22:23], v[50:51], v[68:71]
    v_mfma_f32_4x4x4_16b_bf16 v[72:75], v[22:23], v[52:53], v[72:75]
    v_mfma_f32_4x4x4_16b_bf16 v[76:79], v[22:23], v[54:55], v[76:79]
    v_mfma_f32_4x4x4_16b_bf16 v[80:83], v[22:23], v[56:57], v[80:83]
    v_mfma_f32_4x4x4_16b_bf16 v[84:87], v[22:23], v[58:59], v[84:87]
    v_mfma_f32_4x4x4_16b_bf16 v[88:91], v[22:23], v[60:61], v[88:91]
    v_mfma_f32_4x4x4_16b_bf16 v[92:95], v[22:23], v[62:63], v[92:95]
    v_mov_b32 v26, v17
    v_mov_b32 v27, v17
    v_mul_f32 v24, s84, v16
    s_nop 0
    v_permlane32_swap_b32 v26, v27
    v_add_f32 v26, v26, v27
    v_mov_b32 v27, v26
    s_nop 1
    v_permlane16_swap_b32 v26, v27
    v_add_f32 v25, v26, v27
    v_permlane32_swap_b32 v64, v66
    v_permlane32_swap_b32 v65, v67
    v_permlane32_swap_b32 v68, v70
    v_permlane32_swap_b32 v69, v71
    v_permlane32_swap_b32 v72, v74
    v_permlane32_swap_b32 v73, v75
    v_permlane32_swap_b32 v76, v78
    v_permlane32_swap_b32 v77, v79
    v_permlane32_swap_b32 v80, v82
    v_permlane32_swap_b32 v81, v83
    v_permlane32_swap_b32 v84, v86
    v_permlane32_swap_b32 v85, v87
    v_permlane32_swap_b32 v88, v90
    v_permlane32_swap_b32 v89, v91
    v_permlane32_swap_b32 v92, v94
    v_permlane32_swap_b32 v93, v95
    v_add_f32 v64, v64, v66
    v_add_f32 v65, v65, v67
    v_add_f32 v68, v68, v70
    v_add_f32 v69, v69, v71
    v_add_f32 v72, v72, v74
    v_add_f32 v73, v73, v75
    v_add_f32 v76, v76, v78
    v_add_f32 v77, v77, v79
    v_add_f32 v80, v80, v82
    v_add_f32 v81, v81, v83
    v_add_f32 v84, v84, v86
    v_add_f32 v85, v85, v87
    v_add_f32 v88, v88, v90
    v_add_f32 v89, v89, v91
    v_add_f32 v92, v92, v94
    v_add_f32 v93, v93, v95
    v_permlane16_swap_b32 v64, v65
    v_permlane16_swap_b32 v68, v69
    v_permlane16_swap_b32 v72, v73
    v_permlane16_swap_b32 v76, v77
    v_permlane16_swap_b32 v80, v81
    v_permlane16_swap_b32 v84, v85
    v_permlane16_swap_b32 v88, v89
    v_permlane16_swap_b32 v92, v93
    v_add_f32 v48, v64, v65
    v_add_f32 v49, v68, v69
    v_add_f32 v50, v72, v73
    v_add_f32 v51, v76, v77
    v_add_f32 v52, v80, v81
    v_add_f32 v53, v84, v85
    v_add_f32 v54, v88, v89
    v_add_f32 v55, v92, v93
    ds_write_b128 v28, v[48:51] offset:2048
    ds_write_b128 v28, v[52:55] offset:2064
    ds_write_b64 v29, v[24:25] offset:18432
    v_mfma_f32_16x16x32_bf16 v[32:35], a[64:67], v[12:15], 0
    v_mfma_f32_16x16x32_bf16 v[36:39], a[68:71], v[12:15], 0
    v_mfma_f32_16x16x32_bf16 v[40:43], a[72:75], v[12:15], 0
    v_mfma_f32_16x16x32_bf16 v[44:47], a[76:79], v[12:15], 0
    v_perm_b32 v48, v116, v112, s85
    v_perm_b32 v49, v124, v120, s85
    v_perm_b32 v50, v116, v112, s86
    v_perm_b32 v51, v124, v120, s86
    v_perm_b32 v52, v117, v113, s85
    v_perm_b32 v53, v125, v121, s85
    v_perm_b32 v54, v117, v113, s86
    v_perm_b32 v55, v125, v121, s86
    v_perm_b32 v56, v118, v114, s85
    v_perm_b32 v57, v126, v122, s85
    v_perm_b32 v58, v118, v114, s86
    v_perm_b32 v59, v126, v122, s86
    v_perm_b32 v60, v119, v115, s85
    v_perm_b32 v61, v127, v123, s85
    v_perm_b32 v62, v119, v115, s86
    v_perm_b32 v63, v127, v123, s86
    v_mov_b32_dpp v32, v33 quad_perm:[0,1,2,3] row_mask:0xf bank_mask:0x2
    v_mov_b32_dpp v36, v37 quad_perm:[0,1,2,3] row_mask:0xf bank_mask:0x2
    v_mov_b32_dpp v40, v41 quad_perm:[0,1,2,3] row_mask:0xf bank_mask:0x2
    v_mov_b32_dpp v44, v45 quad_perm:[0,1,2,3] row_mask:0xf bank_mask:0x2
    v_mov_b32_dpp v32, v34 quad_perm:[0,1,2,3] row_mask:0xf bank_mask:0x4
    v_mov_b32_dpp v36, v38 quad_perm:[0,1,2,3] row_mask:0xf bank_mask:0x4
    v_mov_b32_dpp v40, v42 quad_perm:[0,1,2,3] row_mask:0xf bank_mask:0x4
    v_mov_b32_dpp v44, v46 quad_perm:[0,1,2,3] row_mask:0xf bank_mask:0x4
    v_mov_b32_dpp v32, v35 quad_perm:[0,1,2,3] row_mask:0xf bank_mask:0x8
    v_mov_b32_dpp v36, v39 quad_perm:[0,1,2,3] row_mask:0xf bank_mask:0x8
    v_mov_b32_dpp v40, v43 quad_perm:[0,1,2,3] row_mask:0xf bank_mask:0x8
    v_mov_b32_dpp v44, v47 quad_perm:[0,1,2,3] row_mask:0xf bank_mask:0x8
    v_add_f32_dpp v32, v32, v32 row_ror:8 row_mask:0xf bank_mask:0xf
    v_add_f32_dpp v36, v36, v36 row_ror:8 row_mask:0xf bank_mask:0xf
    v_add_f32_dpp v40, v40, v40 row_ror:8 row_mask:0xf bank_mask:0xf
    v_add_f32_dpp v44, v44, v44 row_ror:8 row_mask:0xf bank_mask:0xf
    v_add_f32_dpp v32, v32, v32 row_ror:4 row_mask:0xf bank_mask:0xf
    v_add_f32_dpp v36, v36, v36 row_ror:4 row_mask:0xf bank_mask:0xf
    v_add_f32_dpp v40, v40, v40 row_ror:4 row_mask:0xf bank_mask:0xf
    v_add_f32_dpp v44, v44, v44 row_ror:4 row_mask:0xf bank_mask:0xf
    v_cvt_pk_bf16_f32 v24, v32, v36
    v_cvt_pk_bf16_f32 v25, v40, v44
    v_lshlrev_b32 v32, 16, v24
    v_and_b32 v36, 0xffff0000, v24
    v_lshlrev_b32 v40, 16, v25
    v_and_b32 v44, 0xffff0000, v25
    v_mul_f32 v32, 0x3db504f3, v32
    v_mul_f32 v36, 0x3db504f3, v36
    v_mul_f32 v40, 0x3db504f3, v40
    v_mul_f32 v44, 0x3db504f3, v44
    v_cvt_pk_bf16_f32 v24, v32, v36
    v_cvt_pk_bf16_f32 v25, v40, v44
    v_lshlrev_b32 v32, 16, v24
    v_and_b32 v36, 0xffff0000, v24
    v_lshlrev_b32 v40, 16, v25
    v_and_b32 v44, 0xffff0000, v25
    v_max3_f32 v26, v32, v36, v40
    v_max_f32 v26, v26, v44
    v_mov_b32 v27, v26
    s_nop 1
    v_permlane32_swap_b32 v26, v27
    v_max_f32 v26, v26, v27
    v_mov_b32 v27, v26
    s_nop 1
    v_permlane16_swap_b32 v26, v27
    v_max_f32 v16, v26, v27
    v_mul_f32 v19, s84, v16
    v_fma_f32 v32, v32, s84, -v19
    v_fma_f32 v36, v36, s84, -v19
    v_fma_f32 v40, v40, s84, -v19
    v_fma_f32 v44, v44, s84, -v19
    v_exp_f32 v32, v32
    v_exp_f32 v36, v36
    v_exp_f32 v40, v40
    v_exp_f32 v44, v44
    v_cvt_pk_bf16_f32 v22, v32, v36
    v_cvt_pk_bf16_f32 v23, v40, v44
    v_add_f32 v24, v32, v36
    v_add_f32 v25, v40, v44
    v_add_f32 v24, v24, v25
    v_mov_b32 v17, v24
    v_mfma_f32_4x4x4_16b_bf16 v[64:67], v[22:23], v[48:49], 0
    v_mfma_f32_4x4x4_16b_bf16 v[68:71], v[22:23], v[50:51], 0
    v_mfma_f32_4x4x4_16b_bf16 v[72:75], v[22:23], v[52:53], 0
    v_mfma_f32_4x4x4_16b_bf16 v[76:79], v[22:23], v[54:55], 0
    v_mfma_f32_4x4x4_16b_bf16 v[80:83], v[22:23], v[56:57], 0
    v_mfma_f32_4x4x4_16b_bf16 v[84:87], v[22:23], v[58:59], 0
    v_mfma_f32_4x4x4_16b_bf16 v[88:91], v[22:23], v[60:61], 0
    v_mfma_f32_4x4x4_16b_bf16 v[92:95], v[22:23], v[62:63], 0
    s_waitcnt vmcnt(0)
    v_mov_b32 v20, 1
    s_mov_b64 exec, 1
    buffer_atomic_add v20, v21, s[48:51], s87 offen sc0
    s_mov_b64 exec, -1
    s_add_u32 s89, s97, 96
    s_lshl_b32 s89, s89, 12
    s_add_u32 s89, s89, s83
    buffer_load_dwordx4 a[64:67], v2, s[40:43], s89 offen offset:0 nt
    buffer_load_dwordx4 a[68:71], v2, s[40:43], s89 offen offset:1024 nt
    buffer_load_dwordx4 a[72:75], v2, s[40:43], s89 offen offset:2048 nt
    buffer_load_dwordx4 a[76:79], v2, s[40:43], s89 offen offset:3072 nt
    buffer_load_dwordx4 v[112:115], v3, s[44:47], s89 offen offset:0 nt
    buffer_load_dwordx4 v[116:119], v3, s[44:47], s89 offen offset:1024 nt
    buffer_load_dwordx4 v[120:123], v3, s[44:47], s89 offen offset:2048 nt
    buffer_load_dwordx4 v[124:127], v3, s[44:47], s89 offen offset:3072 nt
    v_mfma_f32_16x16x32_bf16 v[32:35], a[80:83], v[12:15], 0
    v_mfma_f32_16x16x32_bf16 v[36:39], a[84:87], v[12:15], 0
    v_mfma_f32_16x16x32_bf16 v[40:43], a[88:91], v[12:15], 0
    v_mfma_f32_16x16x32_bf16 v[44:47], a[92:95], v[12:15], 0
    v_perm_b32 v48, v100, v96, s85
    v_perm_b32 v49, v108, v104, s85
    v_perm_b32 v50, v100, v96, s86
    v_perm_b32 v51, v108, v104, s86
    v_perm_b32 v52, v101, v97, s85
    v_perm_b32 v53, v109, v105, s85
    v_perm_b32 v54, v101, v97, s86
    v_perm_b32 v55, v109, v105, s86
    v_perm_b32 v56, v102, v98, s85
    v_perm_b32 v57, v110, v106, s85
    v_perm_b32 v58, v102, v98, s86
    v_perm_b32 v59, v110, v106, s86
    v_perm_b32 v60, v103, v99, s85
    v_perm_b32 v61, v111, v107, s85
    v_perm_b32 v62, v103, v99, s86
    v_perm_b32 v63, v111, v107, s86
    v_mov_b32_dpp v32, v33 quad_perm:[0,1,2,3] row_mask:0xf bank_mask:0x2
    v_mov_b32_dpp v36, v37 quad_perm:[0,1,2,3] row_mask:0xf bank_mask:0x2
    v_mov_b32_dpp v40, v41 quad_perm:[0,1,2,3] row_mask:0xf bank_mask:0x2
    v_mov_b32_dpp v44, v45 quad_perm:[0,1,2,3] row_mask:0xf bank_mask:0x2
    v_mov_b32_dpp v32, v34 quad_perm:[0,1,2,3] row_mask:0xf bank_mask:0x4
    v_mov_b32_dpp v36, v38 quad_perm:[0,1,2,3] row_mask:0xf bank_mask:0x4
    v_mov_b32_dpp v40, v42 quad_perm:[0,1,2,3] row_mask:0xf bank_mask:0x4
    v_mov_b32_dpp v44, v46 quad_perm:[0,1,2,3] row_mask:0xf bank_mask:0x4
    v_mov_b32_dpp v32, v35 quad_perm:[0,1,2,3] row_mask:0xf bank_mask:0x8
    v_mov_b32_dpp v36, v39 quad_perm:[0,1,2,3] row_mask:0xf bank_mask:0x8
    v_mov_b32_dpp v40, v43 quad_perm:[0,1,2,3] row_mask:0xf bank_mask:0x8
    v_mov_b32_dpp v44, v47 quad_perm:[0,1,2,3] row_mask:0xf bank_mask:0x8
    v_add_f32_dpp v32, v32, v32 row_ror:8 row_mask:0xf bank_mask:0xf
    v_add_f32_dpp v36, v36, v36 row_ror:8 row_mask:0xf bank_mask:0xf
    v_add_f32_dpp v40, v40, v40 row_ror:8 row_mask:0xf bank_mask:0xf
    v_add_f32_dpp v44, v44, v44 row_ror:8 row_mask:0xf bank_mask:0xf
    v_add_f32_dpp v32, v32, v32 row_ror:4 row_mask:0xf bank_mask:0xf
    v_add_f32_dpp v36, v36, v36 row_ror:4 row_mask:0xf bank_mask:0xf
    v_add_f32_dpp v40, v40, v40 row_ror:4 row_mask:0xf bank_mask:0xf
    v_add_f32_dpp v44, v44, v44 row_ror:4 row_mask:0xf bank_mask:0xf
    v_cvt_pk_bf16_f32 v24, v32, v36
    v_cvt_pk_bf16_f32 v25, v40, v44
    v_lshlrev_b32 v32, 16, v24
    v_and_b32 v36, 0xffff0000, v24
    v_lshlrev_b32 v40, 16, v25
    v_and_b32 v44, 0xffff0000, v25
    v_mul_f32 v32, 0x3db504f3, v32
    v_mul_f32 v36, 0x3db504f3, v36
    v_mul_f32 v40, 0x3db504f3, v40
    v_mul_f32 v44, 0x3db504f3, v44
    v_cvt_pk_bf16_f32 v24, v32, v36
    v_cvt_pk_bf16_f32 v25, v40, v44
    v_lshlrev_b32 v32, 16, v24
    v_and_b32 v36, 0xffff0000, v24
    v_lshlrev_b32 v40, 16, v25
    v_and_b32 v44, 0xffff0000, v25
    v_max3_f32 v26, v32, v36, v40
    v_max_f32 v26, v26, v44
    v_mov_b32 v27, v26
    s_nop 1
    v_permlane32_swap_b32 v26, v27
    v_max_f32 v26, v26, v27
    v_mov_b32 v27, v26
    s_nop 1
    v_permlane16_swap_b32 v26, v27
    v_max3_f32 v26, v26, v27, v16
    v_cmp_gt_f32 vcc, v26, v16
    v_mul_f32 v19, s84, v26
    v_fma_f32 v18, v16, s84, -v19
    v_mov_b32 v16, v26
    v_exp_f32 v18, v18
    v_fma_f32 v32, v32, s84, -v19
    v_fma_f32 v36, v36, s84, -v19
    v_fma_f32 v40, v40, s84, -v19
    v_fma_f32 v44, v44, s84, -v19
    v_exp_f32 v32, v32
    v_exp_f32 v36, v36
    v_exp_f32 v40, v40
    v_exp_f32 v44, v44
    s_cbranch_vccz L_keep4
    v_mul_f32_dpp v64, v18, v64 quad_perm:[0,0,0,0] row_mask:0xf bank_mask:0xf
    v_mul_f32_dpp v65, v18, v65 quad_perm:[1,1,1,1] row_mask:0xf bank_mask:0xf
    v_mul_f32_dpp v66, v18, v66 quad_perm:[2,2,2,2] row_mask:0xf bank_mask:0xf
    v_mul_f32_dpp v67, v18, v67 quad_perm:[3,3,3,3] row_mask:0xf bank_mask:0xf
    v_mul_f32_dpp v68, v18, v68 quad_perm:[0,0,0,0] row_mask:0xf bank_mask:0xf
    v_mul_f32_dpp v69, v18, v69 quad_perm:[1,1,1,1] row_mask:0xf bank_mask:0xf
    v_mul_f32_dpp v70, v18, v70 quad_perm:[2,2,2,2] row_mask:0xf bank_mask:0xf
    v_mul_f32_dpp v71, v18, v71 quad_perm:[3,3,3,3] row_mask:0xf bank_mask:0xf
    v_mul_f32_dpp v72, v18, v72 quad_perm:[0,0,0,0] row_mask:0xf bank_mask:0xf
    v_mul_f32_dpp v73, v18, v73 quad_perm:[1,1,1,1] row_mask:0xf bank_mask:0xf
    v_mul_f32_dpp v74, v18, v74 quad_perm:[2,2,2,2] row_mask:0xf bank_mask:0xf
    v_mul_f32_dpp v75, v18, v75 quad_perm:[3,3,3,3] row_mask:0xf bank_mask:0xf
    v_mul_f32_dpp v76, v18, v76 quad_perm:[0,0,0,0] row_mask:0xf bank_mask:0xf
    v_mul_f32_dpp v77, v18, v77 quad_perm:[1,1,1,1] row_mask:0xf bank_mask:0xf
    v_mul_f32_dpp v78, v18, v78 quad_perm:[2,2,2,2] row_mask:0xf bank_mask:0xf
    v_mul_f32_dpp v79, v18, v79 quad_perm:[3,3,3,3] row_mask:0xf bank_mask:0xf
    v_mul_f32_dpp v80, v18, v80 quad_perm:[0,0,0,0] row_mask:0xf bank_mask:0xf
    v_mul_f32_dpp v81, v18, v81 quad_perm:[1,1,1,1] row_mask:0xf bank_mask:0xf
    v_mul_f32_dpp v82, v18, v82 quad_perm:[2,2,2,2] row_mask:0xf bank_mask:0xf
    v_mul_f32_dpp v83, v18, v83 quad_perm:[3,3,3,3] row_mask:0xf bank_mask:0xf
    v_mul_f32_dpp v84, v18, v84 quad_perm:[0,0,0,0] row_mask:0xf bank_mask:0xf
    v_mul_f32_dpp v85, v18, v85 quad_perm:[1,1,1,1] row_mask:0xf bank_mask:0xf
    v_mul_f32_dpp v86, v18, v86 quad_perm:[2,2,2,2] row_mask:0xf bank_mask:0xf
    v_mul_f32_dpp v87, v18, v87 quad_perm:[3,3,3,3] row_mask:0xf bank_mask:0xf
    v_mul_f32_dpp v88, v18, v88 quad_perm:[0,0,0,0] row_mask:0xf bank_mask:0xf
    v_mul_f32_dpp v89, v18, v89 quad_perm:[1,1,1,1] row_mask:0xf bank_mask:0xf
    v_mul_f32_dpp v90, v18, v90 quad_perm:[2,2,2,2] row_mask:0xf bank_mask:0xf
    v_mul_f32_dpp v91, v18, v91 quad_perm:[3,3,3,3] row_mask:0xf bank_mask:0xf
    v_mul_f32_dpp v92, v18, v92 quad_perm:[0,0,0,0] row_mask:0xf bank_mask:0xf
    v_mul_f32_dpp v93, v18, v93 quad_perm:[1,1,1,1] row_mask:0xf bank_mask:0xf
    v_mul_f32_dpp v94, v18, v94 quad_perm:[2,2,2,2] row_mask:0xf bank_mask:0xf
    v_mul_f32_dpp v95, v18, v95 quad_perm:[3,3,3,3] row_mask:0xf bank_mask:0xf
L_keep4:
    v_cvt_pk_bf16_f32 v22, v32, v36
    v_cvt_pk_bf16_f32 v23, v40, v44
    v_add_f32 v24, v32, v36
    v_add_f32 v25, v40, v44
    v_add_f32 v24, v24, v25
    v_fma_f32 v17, v17, v18, v24
    v_mfma_f32_4x4x4_16b_bf16 v[64:67], v[22:23], v[48:49], v[64:67]
    v_mfma_f32_4x4x4_16b_bf16 v[68:71], v[22:23], v[50:51], v[68:71]
    v_mfma_f32_4x4x4_16b_bf16 v[72:75], v[22:23], v[52:53], v[72:75]
    v_mfma_f32_4x4x4_16b_bf16 v[76:79], v[22:23], v[54:55], v[76:79]
    v_mfma_f32_4x4x4_16b_bf16 v[80:83], v[22:23], v[56:57], v[80:83]
    v_mfma_f32_4x4x4_16b_bf16 v[84:87], v[22:23], v[58:59], v[84:87]
    v_mfma_f32_4x4x4_16b_bf16 v[88:91], v[22:23], v[60:61], v[88:91]
    v_mfma_f32_4x4x4_16b_bf16 v[92:95], v[22:23], v[62:63], v[92:95]
    v_mfma_f32_16x16x32_bf16 v[32:35], a[0:3], v[12:15], 0
    v_mfma_f32_16x16x32_bf16 v[36:39], a[4:7], v[12:15], 0
    v_mfma_f32_16x16x32_bf16 v[40:43], a[8:11], v[12:15], 0
    v_mfma_f32_16x16x32_bf16 v[44:47], a[12:15], v[12:15], 0
    v_perm_b32 v48, v132, v128, s85
    v_perm_b32 v49, v140, v136, s85
    v_perm_b32 v50, v132, v128, s86
    v_perm_b32 v51, v140, v136, s86
    v_perm_b32 v52, v133, v129, s85
    v_perm_b32 v53, v141, v137, s85
    v_perm_b32 v54, v133, v129, s86
    v_perm_b32 v55, v141, v137, s86
    v_perm_b32 v56, v134, v130, s85
    v_perm_b32 v57, v142, v138, s85
    v_perm_b32 v58, v134, v130, s86
    v_perm_b32 v59, v142, v138, s86
    v_perm_b32 v60, v135, v131, s85
    v_perm_b32 v61, v143, v139, s85
    v_perm_b32 v62, v135, v131, s86
    v_perm_b32 v63, v143, v139, s86
    v_mov_b32_dpp v32, v33 quad_perm:[0,1,2,3] row_mask:0xf bank_mask:0x2
    v_mov_b32_dpp v36, v37 quad_perm:[0,1,2,3] row_mask:0xf bank_mask:0x2
    v_mov_b32_dpp v40, v41 quad_perm:[0,1,2,3] row_mask:0xf bank_mask:0x2
    v_mov_b32_dpp v44, v45 quad_perm:[0,1,2,3] row_mask:0xf bank_mask:0x2
    v_mov_b32_dpp v32, v34 quad_perm:[0,1,2,3] row_mask:0xf bank_mask:0x4
    v_mov_b32_dpp v36, v38 quad_perm:[0,1,2,3] row_mask:0xf bank_mask:0x4
    v_mov_b32_dpp v40, v42 quad_perm:[0,1,2,3] row_mask:0xf bank_mask:0x4
    v_mov_b32_dpp v44, v46 quad_perm:[0,1,2,3] row_mask:0xf bank_mask:0x4
    v_mov_b32_dpp v32, v35 quad_perm:[0,1,2,3] row_mask:0xf bank_mask:0x8
    v_mov_b32_dpp v36, v39 quad_perm:[0,1,2,3] row_mask:0xf bank_mask:0x8
    v_mov_b32_dpp v40, v43 quad_perm:[0,1,2,3] row_mask:0xf bank_mask:0x8
    v_mov_b32_dpp v44, v47 quad_perm:[0,1,2,3] row_mask:0xf bank_mask:0x8
    v_add_f32_dpp v32, v32, v32 row_ror:8 row_mask:0xf bank_mask:0xf
    v_add_f32_dpp v36, v36, v36 row_ror:8 row_mask:0xf bank_mask:0xf
    v_add_f32_dpp v40, v40, v40 row_ror:8 row_mask:0xf bank_mask:0xf
    v_add_f32_dpp v44, v44, v44 row_ror:8 row_mask:0xf bank_mask:0xf
    v_add_f32_dpp v32, v32, v32 row_ror:4 row_mask:0xf bank_mask:0xf
    v_add_f32_dpp v36, v36, v36 row_ror:4 row_mask:0xf bank_mask:0xf
    v_add_f32_dpp v40, v40, v40 row_ror:4 row_mask:0xf bank_mask:0xf
    v_add_f32_dpp v44, v44, v44 row_ror:4 row_mask:0xf bank_mask:0xf
    v_cvt_pk_bf16_f32 v24, v32, v36
    v_cvt_pk_bf16_f32 v25, v40, v44
    v_lshlrev_b32 v32, 16, v24
    v_and_b32 v36, 0xffff0000, v24
    v_lshlrev_b32 v40, 16, v25
    v_and_b32 v44, 0xffff0000, v25
    v_mul_f32 v32, 0x3db504f3, v32
    v_mul_f32 v36, 0x3db504f3, v36
    v_mul_f32 v40, 0x3db504f3, v40
    v_mul_f32 v44, 0x3db504f3, v44
    v_cvt_pk_bf16_f32 v24, v32, v36
    v_cvt_pk_bf16_f32 v25, v40, v44
    v_lshlrev_b32 v32, 16, v24
    v_and_b32 v36, 0xffff0000, v24
    v_lshlrev_b32 v40, 16, v25
    v_and_b32 v44, 0xffff0000, v25
    v_max3_f32 v26, v32, v36, v40
    v_max_f32 v26, v26, v44
    v_mov_b32 v27, v26
    s_nop 1
    v_permlane32_swap_b32 v26, v27
    v_max_f32 v26, v26, v27
    v_mov_b32 v27, v26
    s_nop 1
    v_permlane16_swap_b32 v26, v27
    v_max3_f32 v26, v26, v27, v16
    v_cmp_gt_f32 vcc, v26, v16
    v_mul_f32 v19, s84, v26
    v_fma_f32 v18, v16, s84, -v19
    v_mov_b32 v16, v26
    v_exp_f32 v18, v18
    v_fma_f32 v32, v32, s84, -v19
    v_fma_f32 v36, v36, s84, -v19
    v_fma_f32 v40, v40, s84, -v19
    v_fma_f32 v44, v44, s84, -v19
    v_exp_f32 v32, v32
    v_exp_f32 v36, v36
    v_exp_f32 v40, v40
    v_exp_f32 v44, v44
    s_cbranch_vccz L_keep5
    v_mul_f32_dpp v64, v18, v64 quad_perm:[0,0,0,0] row_mask:0xf bank_mask:0xf
    v_mul_f32_dpp v65, v18, v65 quad_perm:[1,1,1,1] row_mask:0xf bank_mask:0xf
    v_mul_f32_dpp v66, v18, v66 quad_perm:[2,2,2,2] row_mask:0xf bank_mask:0xf
    v_mul_f32_dpp v67, v18, v67 quad_perm:[3,3,3,3] row_mask:0xf bank_mask:0xf
    v_mul_f32_dpp v68, v18, v68 quad_perm:[0,0,0,0] row_mask:0xf bank_mask:0xf
    v_mul_f32_dpp v69, v18, v69 quad_perm:[1,1,1,1] row_mask:0xf bank_mask:0xf
    v_mul_f32_dpp v70, v18, v70 quad_perm:[2,2,2,2] row_mask:0xf bank_mask:0xf
    v_mul_f32_dpp v71, v18, v71 quad_perm:[3,3,3,3] row_mask:0xf bank_mask:0xf
    v_mul_f32_dpp v72, v18, v72 quad_perm:[0,0,0,0] row_mask:0xf bank_mask:0xf
    v_mul_f32_dpp v73, v18, v73 quad_perm:[1,1,1,1] row_mask:0xf bank_mask:0xf
    v_mul_f32_dpp v74, v18, v74 quad_perm:[2,2,2,2] row_mask:0xf bank_mask:0xf
    v_mul_f32_dpp v75, v18, v75 quad_perm:[3,3,3,3] row_mask:0xf bank_mask:0xf
    v_mul_f32_dpp v76, v18, v76 quad_perm:[0,0,0,0] row_mask:0xf bank_mask:0xf
    v_mul_f32_dpp v77, v18, v77 quad_perm:[1,1,1,1] row_mask:0xf bank_mask:0xf
    v_mul_f32_dpp v78, v18, v78 quad_perm:[2,2,2,2] row_mask:0xf bank_mask:0xf
    v_mul_f32_dpp v79, v18, v79 quad_perm:[3,3,3,3] row_mask:0xf bank_mask:0xf
    v_mul_f32_dpp v80, v18, v80 quad_perm:[0,0,0,0] row_mask:0xf bank_mask:0xf
    v_mul_f32_dpp v81, v18, v81 quad_perm:[1,1,1,1] row_mask:0xf bank_mask:0xf
    v_mul_f32_dpp v82, v18, v82 quad_perm:[2,2,2,2] row_mask:0xf bank_mask:0xf
    v_mul_f32_dpp v83, v18, v83 quad_perm:[3,3,3,3] row_mask:0xf bank_mask:0xf
    v_mul_f32_dpp v84, v18, v84 quad_perm:[0,0,0,0] row_mask:0xf bank_mask:0xf
    v_mul_f32_dpp v85, v18, v85 quad_perm:[1,1,1,1] row_mask:0xf bank_mask:0xf
    v_mul_f32_dpp v86, v18, v86 quad_perm:[2,2,2,2] row_mask:0xf bank_mask:0xf
    v_mul_f32_dpp v87, v18, v87 quad_perm:[3,3,3,3] row_mask:0xf bank_mask:0xf
    v_mul_f32_dpp v88, v18, v88 quad_perm:[0,0,0,0] row_mask:0xf bank_mask:0xf
    v_mul_f32_dpp v89, v18, v89 quad_perm:[1,1,1,1] row_mask:0xf bank_mask:0xf
    v_mul_f32_dpp v90, v18, v90 quad_perm:[2,2,2,2] row_mask:0xf bank_mask:0xf
    v_mul_f32_dpp v91, v18, v91 quad_perm:[3,3,3,3] row_mask:0xf bank_mask:0xf
    v_mul_f32_dpp v92, v18, v92 quad_perm:[0,0,0,0] row_mask:0xf bank_mask:0xf
    v_mul_f32_dpp v93, v18, v93 quad_perm:[1,1,1,1] row_mask:0xf bank_mask:0xf
    v_mul_f32_dpp v94, v18, v94 quad_perm:[2,2,2,2] row_mask:0xf bank_mask:0xf
    v_mul_f32_dpp v95, v18, v95 quad_perm:[3,3,3,3] row_mask:0xf bank_mask:0xf
L_keep5:
    v_cvt_pk_bf16_f32 v22, v32, v36
    v_cvt_pk_bf16_f32 v23, v40, v44
    v_add_f32 v24, v32, v36
    v_add_f32 v25, v40, v44
    v_add_f32 v24, v24, v25
    v_fma_f32 v17, v17, v18, v24
    v_mfma_f32_4x4x4_16b_bf16 v[64:67], v[22:23], v[48:49], v[64:67]
    v_mfma_f32_4x4x4_16b_bf16 v[68:71], v[22:23], v[50:51], v[68:71]
    v_mfma_f32_4x4x4_16b_bf16 v[72:75], v[22:23], v[52:53], v[72:75]
    v_mfma_f32_4x4x4_16b_bf16 v[76:79], v[22:23], v[54:55], v[76:79]
    v_mfma_f32_4x4x4_16b_bf16 v[80:83], v[22:23], v[56:57], v[80:83]
    v_mfma_f32_4x4x4_16b_bf16 v[84:87], v[22:23], v[58:59], v[84:87]
    v_mfma_f32_4x4x4_16b_bf16 v[88:91], v[22:23], v[60:61], v[88:91]
    v_mfma_f32_4x4x4_16b_bf16 v[92:95], v[22:23], v[62:63], v[92:95]
    s_mov_b32 s90, 0
    s_branch L_loopY
L_loopX:
    s_waitcnt vmcnt(8)
    v_readfirstlane_b32 s88, v20
    s_nop 3
    s_add_u32 s88, s88, 128
    s_cmp_ge_u32 s88, 512
    s_cbranch_scc1 L_exX
    s_lshl_b32 s89, s88, 12
    s_add_u32 s89, s89, s83
    s_waitcnt vmcnt(0)
    v_mov_b32 v20, 1
    s_mov_b64 exec, 1
    buffer_atomic_add v20, v21, s[48:51], s87 offen sc0
    s_mov_b64 exec, -1
    buffer_load_dwordx4 a[64:67], v2, s[40:43], s89 offen offset:0 nt
    buffer_load_dwordx4 a[68:71], v2, s[40:43], s89 offen offset:1024 nt
    buffer_load_dwordx4 a[72:75], v2, s[40:43], s89 offen offset:2048 nt
    buffer_load_dwordx4 a[76:79], v2, s[40:43], s89 offen offset:3072 nt
    buffer_load_dwordx4 v[112:115], v3, s[44:47], s89 offen offset:0 nt
    buffer_load_dwordx4 v[116:119], v3, s[44:47], s89 offen offset:1024 nt
    buffer_load_dwordx4 v[120:123], v3, s[44:47], s89 offen offset:2048 nt
    buffer_load_dwordx4 v[124:127], v3, s[44:47], s89 offen offset:3072 nt
L_compX:
    v_mfma_f32_16x16x32_bf16 v[32:35], a[80:83], v[12:15], 0
    v_mfma_f32_16x16x32_bf16 v[36:39], a[84:87], v[12:15], 0
    v_mfma_f32_16x16x32_bf16 v[40:43], a[88:91], v[12:15], 0
    v_mfma_f32_16x16x32_bf16 v[44:47], a[92:95], v[12:15], 0
    v_perm_b32 v48, v100, v96, s85
    v_perm_b32 v49, v108, v104, s85
    v_perm_b32 v50, v100, v96, s86
    v_perm_b32 v51, v108, v104, s86
    v_perm_b32 v52, v101, v97, s85
    v_perm_b32 v53, v109, v105, s85
    v_perm_b32 v54, v101, v97, s86
    v_perm_b32 v55, v109, v105, s86
    v_perm_b32 v56, v102, v98, s85
    v_perm_b32 v57, v110, v106, s85
    v_perm_b32 v58, v102, v98, s86
    v_perm_b32 v59, v110, v106, s86
    v_perm_b32 v60, v103, v99, s85
    v_perm_b32 v61, v111, v107, s85
    v_perm_b32 v62, v103, v99, s86
    v_perm_b32 v63, v111, v107, s86
    v_mov_b32_dpp v32, v33 quad_perm:[0,1,2,3] row_mask:0xf bank_mask:0x2
    v_mov_b32_dpp v36, v37 quad_perm:[0,1,2,3] row_mask:0xf bank_mask:0x2
    v_mov_b32_dpp v40, v41 quad_perm:[0,1,2,3] row_mask:0xf bank_mask:0x2
    v_mov_b32_dpp v44, v45 quad_perm:[0,1,2,3] row_mask:0xf bank_mask:0x2
    v_mov_b32_dpp v32, v34 quad_perm:[0,1,2,3] row_mask:0xf bank_mask:0x4
    v_mov_b32_dpp v36, v38 quad_perm:[0,1,2,3] row_mask:0xf bank_mask:0x4
    v_mov_b32_dpp v40, v42 quad_perm:[0,1,2,3] row_mask:0xf bank_mask:0x4
    v_mov_b32_dpp v44, v46 quad_perm:[0,1,2,3] row_mask:0xf bank_mask:0x4
    v_mov_b32_dpp v32, v35 quad_perm:[0,1,2,3] row_mask:0xf bank_mask:0x8
    v_mov_b32_dpp v36, v39 quad_perm:[0,1,2,3] row_mask:0xf bank_mask:0x8
    v_mov_b32_dpp v40, v43 quad_perm:[0,1,2,3] row_mask:0xf bank_mask:0x8
    v_mov_b32_dpp v44, v47 quad_perm:[0,1,2,3] row_mask:0xf bank_mask:0x8
    v_add_f32_dpp v32, v32, v32 row_ror:8 row_mask:0xf bank_mask:0xf
    v_add_f32_dpp v36, v36, v36 row_ror:8 row_mask:0xf bank_mask:0xf
    v_add_f32_dpp v40, v40, v40 row_ror:8 row_mask:0xf bank_mask:0xf
    v_add_f32_dpp v44, v44, v44 row_ror:8 row_mask:0xf bank_mask:0xf
    v_add_f32_dpp v32, v32, v32 row_ror:4 row_mask:0xf bank_mask:0xf
    v_add_f32_dpp v36, v36, v36 row_ror:4 row_mask:0xf bank_mask:0xf
    v_add_f32_dpp v40, v40, v40 row_ror:4 row_mask:0xf bank_mask:0xf
    v_add_f32_dpp v44, v44, v44 row_ror:4 row_mask:0xf bank_mask:0xf
    v_cvt_pk_bf16_f32 v24, v32, v36
    v_cvt_pk_bf16_f32 v25, v40, v44
    v_lshlrev_b32 v32, 16, v24
    v_and_b32 v36, 0xffff0000, v24
    v_lshlrev_b32 v40, 16, v25
    v_and_b32 v44, 0xffff0000, v25
    v_mul_f32 v32, 0x3db504f3, v32
    v_mul_f32 v36, 0x3db504f3, v36
    v_mul_f32 v40, 0x3db504f3, v40
    v_mul_f32 v44, 0x3db504f3, v44
    v_cvt_pk_bf16_f32 v24, v32, v36
    v_cvt_pk_bf16_f32 v25, v40, v44
    v_lshlrev_b32 v32, 16, v24
    v_and_b32 v36, 0xffff0000, v24
    v_lshlrev_b32 v40, 16, v25
    v_and_b32 v44, 0xffff0000, v25
    v_max3_f32 v26, v32, v36, v40
    v_max_f32 v26, v26, v44
    v_mov_b32 v27, v26
    s_nop 1
    v_permlane32_swap_b32 v26, v27
    v_max_f32 v26, v26, v27
    v_mov_b32 v27, v26
    s_nop 1
    v_permlane16_swap_b32 v26, v27
    v_max3_f32 v26, v26, v27, v16
    v_cmp_gt_f32 vcc, v26, v16
    v_mul_f32 v19, s84, v26
    v_fma_f32 v18, v16, s84, -v19
    v_mov_b32 v16, v26
    v_exp_f32 v18, v18
    v_fma_f32 v32, v32, s84, -v19
    v_fma_f32 v36, v36, s84, -v19
    v_fma_f32 v40, v40, s84, -v19
    v_fma_f32 v44, v44, s84, -v19
    v_exp_f32 v32, v32
    v_exp_f32 v36, v36
    v_exp_f32 v40, v40
    v_exp_f32 v44, v44
    s_cbranch_vccz L_keep6
    v_mul_f32_dpp v64, v18, v64 quad_perm:[0,0,0,0] row_mask:0xf bank_mask:0xf
    v_mul_f32_dpp v65, v18, v65 quad_perm:[1,1,1,1] row_mask:0xf bank_mask:0xf
    v_mul_f32_dpp v66, v18, v66 quad_perm:[2,2,2,2] row_mask:0xf bank_mask:0xf
    v_mul_f32_dpp v67, v18, v67 quad_perm:[3,3,3,3] row_mask:0xf bank_mask:0xf
    v_mul_f32_dpp v68, v18, v68 quad_perm:[0,0,0,0] row_mask:0xf bank_mask:0xf
    v_mul_f32_dpp v69, v18, v69 quad_perm:[1,1,1,1] row_mask:0xf bank_mask:0xf
    v_mul_f32_dpp v70, v18, v70 quad_perm:[2,2,2,2] row_mask:0xf bank_mask:0xf
    v_mul_f32_dpp v71, v18, v71 quad_perm:[3,3,3,3] row_mask:0xf bank_mask:0xf
    v_mul_f32_dpp v72, v18, v72 quad_perm:[0,0,0,0] row_mask:0xf bank_mask:0xf
    v_mul_f32_dpp v73, v18, v73 quad_perm:[1,1,1,1] row_mask:0xf bank_mask:0xf
    v_mul_f32_dpp v74, v18, v74 quad_perm:[2,2,2,2] row_mask:0xf bank_mask:0xf
    v_mul_f32_dpp v75, v18, v75 quad_perm:[3,3,3,3] row_mask:0xf bank_mask:0xf
    v_mul_f32_dpp v76, v18, v76 quad_perm:[0,0,0,0] row_mask:0xf bank_mask:0xf
    v_mul_f32_dpp v77, v18, v77 quad_perm:[1,1,1,1] row_mask:0xf bank_mask:0xf
    v_mul_f32_dpp v78, v18, v78 quad_perm:[2,2,2,2] row_mask:0xf bank_mask:0xf
    v_mul_f32_dpp v79, v18, v79 quad_perm:[3,3,3,3] row_mask:0xf bank_mask:0xf
    v_mul_f32_dpp v80, v18, v80 quad_perm:[0,0,0,0] row_mask:0xf bank_mask:0xf
    v_mul_f32_dpp v81, v18, v81 quad_perm:[1,1,1,1] row_mask:0xf bank_mask:0xf
    v_mul_f32_dpp v82, v18, v82 quad_perm:[2,2,2,2] row_mask:0xf bank_mask:0xf
    v_mul_f32_dpp v83, v18, v83 quad_perm:[3,3,3,3] row_mask:0xf bank_mask:0xf
    v_mul_f32_dpp v84, v18, v84 quad_perm:[0,0,0,0] row_mask:0xf bank_mask:0xf
    v_mul_f32_dpp v85, v18, v85 quad_perm:[1,1,1,1] row_mask:0xf bank_mask:0xf
    v_mul_f32_dpp v86, v18, v86 quad_perm:[2,2,2,2] row_mask:0xf bank_mask:0xf
    v_mul_f32_dpp v87, v18, v87 quad_perm:[3,3,3,3] row_mask:0xf bank_mask:0xf
    v_mul_f32_dpp v88, v18, v88 quad_perm:[0,0,0,0] row_mask:0xf bank_mask:0xf
    v_mul_f32_dpp v89, v18, v89 quad_perm:[1,1,1,1] row_mask:0xf bank_mask:0xf
    v_mul_f32_dpp v90, v18, v90 quad_perm:[2,2,2,2] row_mask:0xf bank_mask:0xf
    v_mul_f32_dpp v91, v18, v91 quad_perm:[3,3,3,3] row_mask:0xf bank_mask:0xf
    v_mul_f32_dpp v92, v18, v92 quad_perm:[0,0,0,0] row_mask:0xf bank_mask:0xf
    v_mul_f32_dpp v93, v18, v93 quad_perm:[1,1,1,1] row_mask:0xf bank_mask:0xf
    v_mul_f32_dpp v94, v18, v94 quad_perm:[2,2,2,2] row_mask:0xf bank_mask:0xf
    v_mul_f32_dpp v95, v18, v95 quad_perm:[3,3,3,3] row_mask:0xf bank_mask:0xf
L_keep6:
    v_cvt_pk_bf16_f32 v22, v32, v36
    v_cvt_pk_bf16_f32 v23, v40, v44
    v_add_f32 v24, v32, v36
    v_add_f32 v25, v40, v44
    v_add_f32 v24, v24, v25
    v_fma_f32 v17, v17, v18, v24
    v_mfma_f32_4x4x4_16b_bf16 v[64:67], v[22:23], v[48:49], v[64:67]
    v_mfma_f32_4x4x4_16b_bf16 v[68:71], v[22:23], v[50:51], v[68:71]
    v_mfma_f32_4x4x4_16b_bf16 v[72:75], v[22:23], v[52:53], v[72:75]
    v_mfma_f32_4x4x4_16b_bf16 v[76:79], v[22:23], v[54:55], v[76:79]
    v_mfma_f32_4x4x4_16b_bf16 v[80:83], v[22:23], v[56:57], v[80:83]
    v_mfma_f32_4x4x4_16b_bf16 v[84:87], v[22:23], v[58:59], v[84:87]
    v_mfma_f32_4x4x4_16b_bf16 v[88:91], v[22:23], v[60:61], v[88:91]
    v_mfma_f32_4x4x4_16b_bf16 v[92:95], v[22:23], v[62:63], v[92:95]
    s_cmp_lg_u32 s90, 0
    s_cbranch_scc1 L_tail
L_loopY:
    s_waitcnt vmcnt(8)
    v_readfirstlane_b32 s88, v20
    s_nop 3
    s_add_u32 s88, s88, 128
    s_cmp_ge_u32 s88, 512
    s_cbranch_scc1 L_exY
    s_lshl_b32 s89, s88, 12
    s_add_u32 s89, s89, s83
    s_waitcnt vmcnt(0)
    v_mov_b32 v20, 1
    s_mov_b64 exec, 1
    buffer_atomic_add v20, v21, s[48:51], s87 offen sc0
    s_mov_b64 exec, -1
    buffer_load_dwordx4 a[80:83], v2, s[40:43], s89 offen offset:0 nt
    buffer_load_dwordx4 a[84:87], v2, s[40:43], s89 offen offset:1024 nt
    buffer_load_dwordx4 a[88:91], v2, s[40:43], s89 offen offset:2048 nt
    buffer_load_dwordx4 a[92:95], v2, s[40:43], s89 offen offset:3072 nt
    buffer_load_dwordx4 v[96:99], v3, s[44:47], s89 offen offset:0 nt
    buffer_load_dwordx4 v[100:103], v3, s[44:47], s89 offen offset:1024 nt
    buffer_load_dwordx4 v[104:107], v3, s[44:47], s89 offen offset:2048 nt
    buffer_load_dwordx4 v[108:111], v3, s[44:47], s89 offen offset:3072 nt
L_compY:
    v_mfma_f32_16x16x32_bf16 v[32:35], a[64:67], v[12:15], 0
    v_mfma_f32_16x16x32_bf16 v[36:39], a[68:71], v[12:15], 0
    v_mfma_f32_16x16x32_bf16 v[40:43], a[72:75], v[12:15], 0
    v_mfma_f32_16x16x32_bf16 v[44:47], a[76:79], v[12:15], 0
    v_perm_b32 v48, v116, v112, s85
    v_perm_b32 v49, v124, v120, s85
    v_perm_b32 v50, v116, v112, s86
    v_perm_b32 v51, v124, v120, s86
    v_perm_b32 v52, v117, v113, s85
    v_perm_b32 v53, v125, v121, s85
    v_perm_b32 v54, v117, v113, s86
    v_perm_b32 v55, v125, v121, s86
    v_perm_b32 v56, v118, v114, s85
    v_perm_b32 v57, v126, v122, s85
    v_perm_b32 v58, v118, v114, s86
    v_perm_b32 v59, v126, v122, s86
    v_perm_b32 v60, v119, v115, s85
    v_perm_b32 v61, v127, v123, s85
    v_perm_b32 v62, v119, v115, s86
    v_perm_b32 v63, v127, v123, s86
    v_mov_b32_dpp v32, v33 quad_perm:[0,1,2,3] row_mask:0xf bank_mask:0x2
    v_mov_b32_dpp v36, v37 quad_perm:[0,1,2,3] row_mask:0xf bank_mask:0x2
    v_mov_b32_dpp v40, v41 quad_perm:[0,1,2,3] row_mask:0xf bank_mask:0x2
    v_mov_b32_dpp v44, v45 quad_perm:[0,1,2,3] row_mask:0xf bank_mask:0x2
    v_mov_b32_dpp v32, v34 quad_perm:[0,1,2,3] row_mask:0xf bank_mask:0x4
    v_mov_b32_dpp v36, v38 quad_perm:[0,1,2,3] row_mask:0xf bank_mask:0x4
    v_mov_b32_dpp v40, v42 quad_perm:[0,1,2,3] row_mask:0xf bank_mask:0x4
    v_mov_b32_dpp v44, v46 quad_perm:[0,1,2,3] row_mask:0xf bank_mask:0x4
    v_mov_b32_dpp v32, v35 quad_perm:[0,1,2,3] row_mask:0xf bank_mask:0x8
    v_mov_b32_dpp v36, v39 quad_perm:[0,1,2,3] row_mask:0xf bank_mask:0x8
    v_mov_b32_dpp v40, v43 quad_perm:[0,1,2,3] row_mask:0xf bank_mask:0x8
    v_mov_b32_dpp v44, v47 quad_perm:[0,1,2,3] row_mask:0xf bank_mask:0x8
    v_add_f32_dpp v32, v32, v32 row_ror:8 row_mask:0xf bank_mask:0xf
    v_add_f32_dpp v36, v36, v36 row_ror:8 row_mask:0xf bank_mask:0xf
    v_add_f32_dpp v40, v40, v40 row_ror:8 row_mask:0xf bank_mask:0xf
    v_add_f32_dpp v44, v44, v44 row_ror:8 row_mask:0xf bank_mask:0xf
    v_add_f32_dpp v32, v32, v32 row_ror:4 row_mask:0xf bank_mask:0xf
    v_add_f32_dpp v36, v36, v36 row_ror:4 row_mask:0xf bank_mask:0xf
    v_add_f32_dpp v40, v40, v40 row_ror:4 row_mask:0xf bank_mask:0xf
    v_add_f32_dpp v44, v44, v44 row_ror:4 row_mask:0xf bank_mask:0xf
    v_cvt_pk_bf16_f32 v24, v32, v36
    v_cvt_pk_bf16_f32 v25, v40, v44
    v_lshlrev_b32 v32, 16, v24
    v_and_b32 v36, 0xffff0000, v24
    v_lshlrev_b32 v40, 16, v25
    v_and_b32 v44, 0xffff0000, v25
    v_mul_f32 v32, 0x3db504f3, v32
    v_mul_f32 v36, 0x3db504f3, v36
    v_mul_f32 v40, 0x3db504f3, v40
    v_mul_f32 v44, 0x3db504f3, v44
    v_cvt_pk_bf16_f32 v24, v32, v36
    v_cvt_pk_bf16_f32 v25, v40, v44
    v_lshlrev_b32 v32, 16, v24
    v_and_b32 v36, 0xffff0000, v24
    v_lshlrev_b32 v40, 16, v25
    v_and_b32 v44, 0xffff0000, v25
    v_max3_f32 v26, v32, v36, v40
    v_max_f32 v26, v26, v44
    v_mov_b32 v27, v26
    s_nop 1
    v_permlane32_swap_b32 v26, v27
    v_max_f32 v26, v26, v27
    v_mov_b32 v27, v26
    s_nop 1
    v_permlane16_swap_b32 v26, v27
    v_max3_f32 v26, v26, v27, v16
    v_cmp_gt_f32 vcc, v26, v16
    v_mul_f32 v19, s84, v26
    v_fma_f32 v18, v16, s84, -v19
    v_mov_b32 v16, v26
    v_exp_f32 v18, v18
    v_fma_f32 v32, v32, s84, -v19
    v_fma_f32 v36, v36, s84, -v19
    v_fma_f32 v40, v40, s84, -v19
    v_fma_f32 v44, v44, s84, -v19
    v_exp_f32 v32, v32
    v_exp_f32 v36, v36
    v_exp_f32 v40, v40
    v_exp_f32 v44, v44
    s_cbranch_vccz L_keep7
    v_mul_f32_dpp v64, v18, v64 quad_perm:[0,0,0,0] row_mask:0xf bank_mask:0xf
    v_mul_f32_dpp v65, v18, v65 quad_perm:[1,1,1,1] row_mask:0xf bank_mask:0xf
    v_mul_f32_dpp v66, v18, v66 quad_perm:[2,2,2,2] row_mask:0xf bank_mask:0xf
    v_mul_f32_dpp v67, v18, v67 quad_perm:[3,3,3,3] row_mask:0xf bank_mask:0xf
    v_mul_f32_dpp v68, v18, v68 quad_perm:[0,0,0,0] row_mask:0xf bank_mask:0xf
    v_mul_f32_dpp v69, v18, v69 quad_perm:[1,1,1,1] row_mask:0xf bank_mask:0xf
    v_mul_f32_dpp v70, v18, v70 quad_perm:[2,2,2,2] row_mask:0xf bank_mask:0xf
    v_mul_f32_dpp v71, v18, v71 quad_perm:[3,3,3,3] row_mask:0xf bank_mask:0xf
    v_mul_f32_dpp v72, v18, v72 quad_perm:[0,0,0,0] row_mask:0xf bank_mask:0xf
    v_mul_f32_dpp v73, v18, v73 quad_perm:[1,1,1,1] row_mask:0xf bank_mask:0xf
    v_mul_f32_dpp v74, v18, v74 quad_perm:[2,2,2,2] row_mask:0xf bank_mask:0xf
    v_mul_f32_dpp v75, v18, v75 quad_perm:[3,3,3,3] row_mask:0xf bank_mask:0xf
    v_mul_f32_dpp v76, v18, v76 quad_perm:[0,0,0,0] row_mask:0xf bank_mask:0xf
    v_mul_f32_dpp v77, v18, v77 quad_perm:[1,1,1,1] row_mask:0xf bank_mask:0xf
    v_mul_f32_dpp v78, v18, v78 quad_perm:[2,2,2,2] row_mask:0xf bank_mask:0xf
    v_mul_f32_dpp v79, v18, v79 quad_perm:[3,3,3,3] row_mask:0xf bank_mask:0xf
    v_mul_f32_dpp v80, v18, v80 quad_perm:[0,0,0,0] row_mask:0xf bank_mask:0xf
    v_mul_f32_dpp v81, v18, v81 quad_perm:[1,1,1,1] row_mask:0xf bank_mask:0xf
    v_mul_f32_dpp v82, v18, v82 quad_perm:[2,2,2,2] row_mask:0xf bank_mask:0xf
    v_mul_f32_dpp v83, v18, v83 quad_perm:[3,3,3,3] row_mask:0xf bank_mask:0xf
    v_mul_f32_dpp v84, v18, v84 quad_perm:[0,0,0,0] row_mask:0xf bank_mask:0xf
    v_mul_f32_dpp v85, v18, v85 quad_perm:[1,1,1,1] row_mask:0xf bank_mask:0xf
    v_mul_f32_dpp v86, v18, v86 quad_perm:[2,2,2,2] row_mask:0xf bank_mask:0xf
    v_mul_f32_dpp v87, v18, v87 quad_perm:[3,3,3,3] row_mask:0xf bank_mask:0xf
    v_mul_f32_dpp v88, v18, v88 quad_perm:[0,0,0,0] row_mask:0xf bank_mask:0xf
    v_mul_f32_dpp v89, v18, v89 quad_perm:[1,1,1,1] row_mask:0xf bank_mask:0xf
    v_mul_f32_dpp v90, v18, v90 quad_perm:[2,2,2,2] row_mask:0xf bank_mask:0xf
    v_mul_f32_dpp v91, v18, v91 quad_perm:[3,3,3,3] row_mask:0xf bank_mask:0xf
    v_mul_f32_dpp v92, v18, v92 quad_perm:[0,0,0,0] row_mask:0xf bank_mask:0xf
    v_mul_f32_dpp v93, v18, v93 quad_perm:[1,1,1,1] row_mask:0xf bank_mask:0xf
    v_mul_f32_dpp v94, v18, v94 quad_perm:[2,2,2,2] row_mask:0xf bank_mask:0xf
    v_mul_f32_dpp v95, v18, v95 quad_perm:[3,3,3,3] row_mask:0xf bank_mask:0xf
L_keep7:
    v_cvt_pk_bf16_f32 v22, v32, v36
    v_cvt_pk_bf16_f32 v23, v40, v44
    v_add_f32 v24, v32, v36
    v_add_f32 v25, v40, v44
    v_add_f32 v24, v24, v25
    v_fma_f32 v17, v17, v18, v24
    v_mfma_f32_4x4x4_16b_bf16 v[64:67], v[22:23], v[48:49], v[64:67]
    v_mfma_f32_4x4x4_16b_bf16 v[68:71], v[22:23], v[50:51], v[68:71]
    v_mfma_f32_4x4x4_16b_bf16 v[72:75], v[22:23], v[52:53], v[72:75]
    v_mfma_f32_4x4x4_16b_bf16 v[76:79], v[22:23], v[54:55], v[76:79]
    v_mfma_f32_4x4x4_16b_bf16 v[80:83], v[22:23], v[56:57], v[80:83]
    v_mfma_f32_4x4x4_16b_bf16 v[84:87], v[22:23], v[58:59], v[84:87]
    v_mfma_f32_4x4x4_16b_bf16 v[88:91], v[22:23], v[60:61], v[88:91]
    v_mfma_f32_4x4x4_16b_bf16 v[92:95], v[22:23], v[62:63], v[92:95]
    s_cmp_lg_u32 s90, 0
    s_cbranch_scc1 L_tail
    s_branch L_loopX
L_exX:
    buffer_load_dwordx4 v[192:195], v0, s[56:59], s3 offen offset:0
    buffer_load_dwordx4 v[196:199], v0, s[56:59], s3 offen offset:1024
    buffer_load_dwordx4 v[200:203], v0, s[56:59], s3 offen offset:2048
    buffer_load_dwordx4 v[204:207], v0, s[56:59], s3 offen offset:3072
    s_add_u32 s91, s3, 4096
    buffer_load_dwordx4 v[208:211], v0, s[56:59], s91 offen offset:0
    buffer_load_dwordx4 v[212:215], v0, s[56:59], s91 offen offset:1024
    buffer_load_dwordx4 v[216:219], v0, s[56:59], s91 offen offset:2048
    buffer_load_dwordx4 v[220:223], v0, s[56:59], s91 offen offset:3072
    s_add_u32 s91, s3, 8192
    buffer_load_dwordx4 v[224:227], v0, s[56:59], s91 offen offset:0
    buffer_load_dwordx4 v[228:231], v0, s[56:59], s91 offen offset:1024
    buffer_load_dwordx4 v[232:235], v0, s[56:59], s91 offen offset:2048
    buffer_load_dwordx4 v[236:239], v0, s[56:59], s91 offen offset:3072
    s_add_u32 s91, s3, 12288
    buffer_load_dwordx4 v[240:243], v0, s[56:59], s91 offen offset:0
    buffer_load_dwordx4 v[244:247], v0, s[56:59], s91 offen offset:1024
    buffer_load_dwordx4 v[248:251], v0, s[56:59], s91 offen offset:2048
    buffer_load_dwordx4 v[252:255], v0, s[56:59], s91 offen offset:3072
    s_mov_b32 s90, 1
    s_waitcnt vmcnt(16)
    s_branch L_compX
L_exY:
    buffer_load_dwordx4 v[192:195], v0, s[56:59], s3 offen offset:0
    buffer_load_dwordx4 v[196:199], v0, s[56:59], s3 offen offset:1024
    buffer_load_dwordx4 v[200:203], v0, s[56:59], s3 offen offset:2048
    buffer_load_dwordx4 v[204:207], v0, s[56:59], s3 offen offset:3072
    s_add_u32 s91, s3, 4096
    buffer_load_dwordx4 v[208:211], v0, s[56:59], s91 offen offset:0
    buffer_load_dwordx4 v[212:215], v0, s[56:59], s91 offen offset:1024
    buffer_load_dwordx4 v[216:219], v0, s[56:59], s91 offen offset:2048
    buffer_load_dwordx4 v[220:223], v0, s[56:59], s91 offen offset:3072
    s_add_u32 s91, s3, 8192
    buffer_load_dwordx4 v[224:227], v0, s[56:59], s91 offen offset:0
    buffer_load_dwordx4 v[228:231], v0, s[56:59], s91 offen offset:1024
    buffer_load_dwordx4 v[232:235], v0, s[56:59], s91 offen offset:2048
    buffer_load_dwordx4 v[236:239], v0, s[56:59], s91 offen offset:3072
    s_add_u32 s91, s3, 12288
    buffer_load_dwordx4 v[240:243], v0, s[56:59], s91 offen offset:0
    buffer_load_dwordx4 v[244:247], v0, s[56:59], s91 offen offset:1024
    buffer_load_dwordx4 v[248:251], v0, s[56:59], s91 offen offset:2048
    buffer_load_dwordx4 v[252:255], v0, s[56:59], s91 offen offset:3072
    s_mov_b32 s90, 1
    s_waitcnt vmcnt(16)
    s_branch L_compY
L_tail:
    v_mov_b32 v26, v17
    v_mov_b32 v27, v17
    v_mul_f32 v24, s84, v16
    s_nop 0
    v_permlane32_swap_b32 v26, v27
    v_add_f32 v26, v26, v27
    v_mov_b32 v27, v26
    s_nop 1
    v_permlane16_swap_b32 v26, v27
    v_add_f32 v25, v26, v27
    v_permlane32_swap_b32 v64, v66
    v_permlane32_swap_b32 v65, v67
    v_permlane32_swap_b32 v68, v70
    v_permlane32_swap_b32 v69, v71
    v_permlane32_swap_b32 v72, v74
    v_permlane32_swap_b32 v73, v75
    v_permlane32_swap_b32 v76, v78
    v_permlane32_swap_b32 v77, v79
    v_permlane32_swap_b32 v80, v82
    v_permlane32_swap_b32 v81, v83
    v_permlane32_swap_b32 v84, v86
    v_permlane32_swap_b32 v85, v87
    v_permlane32_swap_b32 v88, v90
    v_permlane32_swap_b32 v89, v91
    v_permlane32_swap_b32 v92, v94
    v_permlane32_swap_b32 v93, v95
    v_add_f32 v64, v64, v66
    v_add_f32 v65, v65, v67
    v_add_f32 v68, v68, v70
    v_add_f32 v69, v69, v71
    v_add_f32 v72, v72, v74
    v_add_f32 v73, v73, v75
    v_add_f32 v76, v76, v78
    v_add_f32 v77, v77, v79
    v_add_f32 v80, v80, v82
    v_add_f32 v81, v81, v83
    v_add_f32 v84, v84, v86
    v_add_f32 v85, v85, v87
    v_add_f32 v88, v88, v90
    v_add_f32 v89, v89, v91
    v_add_f32 v92, v92, v94
    v_add_f32 v93, v93, v95
    v_permlane16_swap_b32 v64, v65
    v_permlane16_swap_b32 v68, v69
    v_permlane16_swap_b32 v72, v73
    v_permlane16_swap_b32 v76, v77
    v_permlane16_swap_b32 v80, v81
    v_permlane16_swap_b32 v84, v85
    v_permlane16_swap_b32 v88, v89
    v_permlane16_swap_b32 v92, v93
    v_add_f32 v48, v64, v65
    v_add_f32 v49, v68, v69
    v_add_f32 v50, v72, v73
    v_add_f32 v51, v76, v77
    v_add_f32 v52, v80, v81
    v_add_f32 v53, v84, v85
    v_add_f32 v54, v88, v89
    v_add_f32 v55, v92, v93
    ds_write_b128 v28, v[48:51] offset:10240
    ds_write_b128 v28, v[52:55] offset:10256
    ds_write_b64 v29, v[24:25] offset:18560
    s_waitcnt lgkmcnt(0)
    s_barrier
    ds_read_b64 v[32:33], v30 offset:2048
    ds_read_b64 v[40:41], v31 offset:18432
    ds_read_b64 v[34:35], v30 offset:4096
    ds_read_b64 v[42:43], v31 offset:18464
    ds_read_b64 v[36:37], v30 offset:6144
    ds_read_b64 v[44:45], v31 offset:18496
    ds_read_b64 v[38:39], v30 offset:8192
    ds_read_b64 v[46:47], v31 offset:18528
    ds_read_b64 v[48:49], v30 offset:10240
    ds_read_b64 v[56:57], v31 offset:18560
    ds_read_b64 v[50:51], v30 offset:12288
    ds_read_b64 v[58:59], v31 offset:18592
    ds_read_b64 v[52:53], v30 offset:14336
    ds_read_b64 v[60:61], v31 offset:18624
    ds_read_b64 v[54:55], v30 offset:16384
    ds_read_b64 v[62:63], v31 offset:18656
    s_waitcnt lgkmcnt(8)
    v_max3_f32 v24, v40, v42, v44
    v_max_f32 v24, v24, v46
    v_sub_f32 v40, v40, v24
    v_sub_f32 v42, v42, v24
    v_sub_f32 v44, v44, v24
    v_sub_f32 v46, v46, v24
    v_exp_f32 v40, v40
    v_exp_f32 v42, v42
    v_exp_f32 v44, v44
    v_exp_f32 v46, v46
    v_mov_b32 v67, s76
    v_mul_f32 v25, v40, v41
    v_mul_f32 v64, v40, v32
    v_mul_f32 v65, v40, v33
    v_fmac_f32 v25, v42, v43
    v_fmac_f32 v64, v42, v34
    v_fmac_f32 v65, v42, v35
    v_fmac_f32 v25, v44, v45
    v_fmac_f32 v64, v44, v36
    v_fmac_f32 v65, v44, v37
    v_fmac_f32 v25, v46, v47
    v_fmac_f32 v64, v46, v38
    v_fmac_f32 v65, v46, v39
    v_rcp_f32 v26, v25
    v_log_f32 v27, v25
    v_mul_f32 v64, v64, v26
    v_mul_f32 v65, v65, v26
    v_add_f32 v66, v24, v27
    buffer_store_dwordx4 v[64:67], v3, s[48:51], s20 offen sc1
    s_waitcnt lgkmcnt(0)
    v_max3_f32 v24, v56, v58, v60
    v_max_f32 v24, v24, v62
    v_sub_f32 v56, v56, v24
    v_sub_f32 v58, v58, v24
    v_sub_f32 v60, v60, v24
    v_sub_f32 v62, v62, v24
    v_exp_f32 v56, v56
    v_exp_f32 v58, v58
    v_exp_f32 v60, v60
    v_exp_f32 v62, v62
    v_mov_b32 v71, s76
    v_mul_f32 v25, v56, v57
    v_mul_f32 v68, v56, v48
    v_mul_f32 v69, v56, v49
    v_fmac_f32 v25, v58, v59
    v_fmac_f32 v68, v58, v50
    v_fmac_f32 v69, v58, v51
    v_fmac_f32 v25, v60, v61
    v_fmac_f32 v68, v60, v52
    v_fmac_f32 v69, v60, v53
    v_fmac_f32 v25, v62, v63
    v_fmac_f32 v68, v62, v54
    v_fmac_f32 v69, v62, v55
    v_rcp_f32 v26, v25
    v_log_f32 v27, v25
    v_mul_f32 v68, v68, v26
    v_mul_f32 v69, v69, v26
    v_add_f32 v70, v24, v27
    buffer_store_dwordx4 v[68:71], v3, s[48:51], s26 offen sc1
    s_waitcnt vmcnt(2)
    buffer_load_dwordx4 v[128:131], v0, s[52:55], s3 offen offset:0
    buffer_load_dwordx4 v[132:135], v0, s[52:55], s3 offen offset:1024
    buffer_load_dwordx4 v[136:139], v0, s[52:55], s3 offen offset:2048
    buffer_load_dwordx4 v[140:143], v0, s[52:55], s3 offen offset:3072
    s_add_u32 s91, s3, 4096
    buffer_load_dwordx4 v[144:147], v0, s[52:55], s91 offen offset:0
    buffer_load_dwordx4 v[148:151], v0, s[52:55], s91 offen offset:1024
    buffer_load_dwordx4 v[152:155], v0, s[52:55], s91 offen offset:2048
    buffer_load_dwordx4 v[156:159], v0, s[52:55], s91 offen offset:3072
    s_add_u32 s91, s3, 8192
    buffer_load_dwordx4 v[160:163], v0, s[52:55], s91 offen offset:0
    buffer_load_dwordx4 v[164:167], v0, s[52:55], s91 offen offset:1024
    buffer_load_dwordx4 v[168:171], v0, s[52:55], s91 offen offset:2048
    buffer_load_dwordx4 v[172:175], v0, s[52:55], s91 offen offset:3072
    s_add_u32 s91, s3, 12288
    buffer_load_dwordx4 v[176:179], v0, s[52:55], s91 offen offset:0
    buffer_load_dwordx4 v[180:183], v0, s[52:55], s91 offen offset:1024
    buffer_load_dwordx4 v[184:187], v0, s[52:55], s91 offen offset:2048
    buffer_load_dwordx4 v[188:191], v0, s[52:55], s91 offen offset:3072
    v_perm_b32 v48, v196, v192, s85
    v_perm_b32 v49, v204, v200, s85
    v_perm_b32 v50, v196, v192, s86
    v_perm_b32 v51, v204, v200, s86
    v_perm_b32 v52, v197, v193, s85
    v_perm_b32 v53, v205, v201, s85
    v_perm_b32 v54, v197, v193, s86
    v_perm_b32 v55, v205, v201, s86
    v_perm_b32 v56, v198, v194, s85
    v_perm_b32 v57, v206, v202, s85
    v_perm_b32 v58, v198, v194, s86
    v_perm_b32 v59, v206, v202, s86
    v_perm_b32 v60, v199, v195, s85
    v_perm_b32 v61, v207, v203, s85
    v_perm_b32 v62, v199, v195, s86
    v_perm_b32 v63, v207, v203, s86
    v_perm_b32 v192, v212, v208, s85
    v_perm_b32 v193, v220, v216, s85
    v_perm_b32 v194, v212, v208, s86
    v_perm_b32 v195, v220, v216, s86
    v_perm_b32 v196, v213, v209, s85
    v_perm_b32 v197, v221, v217, s85
    v_perm_b32 v198, v213, v209, s86
    v_perm_b32 v199, v221, v217, s86
    v_perm_b32 v200, v214, v210, s85
    v_perm_b32 v201, v222, v218, s85
    v_perm_b32 v202, v214, v210, s86
    v_perm_b32 v203, v222, v218, s86
    v_perm_b32 v204, v215, v211, s85
    v_perm_b32 v205, v223, v219, s85
    v_perm_b32 v206, v215, v211, s86
    v_perm_b32 v207, v223, v219, s86
    v_perm_b32 v208, v228, v224, s85
    v_perm_b32 v209, v236, v232, s85
    v_perm_b32 v210, v228, v224, s86
    v_perm_b32 v211, v236, v232, s86
    v_perm_b32 v212, v229, v225, s85
    v_perm_b32 v213, v237, v233, s85
    v_perm_b32 v214, v229, v225, s86
    v_perm_b32 v215, v237, v233, s86
    v_perm_b32 v216, v230, v226, s85
    v_perm_b32 v217, v238, v234, s85
    v_perm_b32 v218, v230, v226, s86
    v_perm_b32 v219, v238, v234, s86
    v_perm_b32 v220, v231, v227, s85
    v_perm_b32 v221, v239, v235, s85
    v_perm_b32 v222, v231, v227, s86
    v_perm_b32 v223, v239, v235, s86
    v_perm_b32 v224, v244, v240, s85
    v_perm_b32 v225, v252, v248, s85
    v_perm_b32 v226, v244, v240, s86
    v_perm_b32 v227, v252, v248, s86
    v_perm_b32 v228, v245, v241, s85
    v_perm_b32 v229, v253, v249, s85
    v_perm_b32 v230, v245, v241, s86
    v_perm_b32 v231, v253, v249, s86
    v_perm_b32 v232, v246, v242, s85
    v_perm_b32 v233, v254, v250, s85
    v_perm_b32 v234, v246, v242, s86
    v_perm_b32 v235, v254, v250, s86
    v_perm_b32 v236, v247, v243, s85
    v_perm_b32 v237, v255, v251, s85
    v_perm_b32 v238, v247, v243, s86
    v_perm_b32 v239, v255, v251, s86
    s_cmp_ge_u32 s78, 2
    s_cbranch_scc1 L_nogather
    buffer_load_dwordx4 v[96:99], v3, s[48:51], s21 offen offset:0 sc1
    buffer_load_dwordx4 v[100:103], v3, s[48:51], s21 offen offset:1024 sc1
    buffer_load_dwordx4 v[104:107], v3, s[48:51], s21 offen offset:2048 sc1
    buffer_load_dwordx4 v[108:111], v3, s[48:51], s21 offen offset:3072 sc1
    buffer_load_dwordx4 v[112:115], v3, s[48:51], s25 offen offset:0 sc1
    buffer_load_dwordx4 v[116:119], v3, s[48:51], s25 offen offset:1024 sc1
    buffer_load_dwordx4 v[120:123], v3, s[48:51], s25 offen offset:2048 sc1
    buffer_load_dwordx4 v[124:127], v3, s[48:51], s25 offen offset:3072 sc1
    s_branch L_ga
L_nogather:
    s_cmp_lg_u32 s78, 2
    s_cbranch_scc1 L_now2
    buffer_load_dwordx4 v[96:99], v3, s[48:51], s23 offen offset:0 sc1
    buffer_load_dwordx4 v[100:103], v3, s[48:51], s23 offen offset:1024 sc1
    buffer_load_dwordx4 v[104:107], v3, s[48:51], s23 offen offset:2048 sc1
    buffer_load_dwordx4 v[108:111], v3, s[48:51], s23 offen offset:3072 sc1
    s_waitcnt vmcnt(4)
    s_branch L_pa
L_now2:
    s_waitcnt vmcnt(0)
    s_branch L_pa
L_ga:
    s_waitcnt vmcnt(8)
L_pa:
    v_perm_b32 v240, v132, v128, s85
    v_perm_b32 v241, v140, v136, s85
    v_perm_b32 v242, v132, v128, s86
    v_perm_b32 v243, v140, v136, s86
    v_perm_b32 v244, v133, v129, s85
    v_perm_b32 v245, v141, v137, s85
    v_perm_b32 v246, v133, v129, s86
    v_perm_b32 v247, v141, v137, s86
    v_perm_b32 v248, v134, v130, s85
    v_perm_b32 v249, v142, v138, s85
    v_perm_b32 v250, v134, v130, s86
    v_perm_b32 v251, v142, v138, s86
    v_perm_b32 v252, v135, v131, s85
    v_perm_b32 v253, v143, v139, s85
    v_perm_b32 v254, v135, v131, s86
    v_perm_b32 v255, v143, v139, s86
    v_perm_b32 v128, v148, v144, s85
    v_perm_b32 v129, v156, v152, s85
    v_perm_b32 v130, v148, v144, s86
    v_perm_b32 v131, v156, v152, s86
    v_perm_b32 v132, v149, v145, s85
    v_perm_b32 v133, v157, v153, s85
    v_perm_b32 v134, v149, v145, s86
    v_perm_b32 v135, v157, v153, s86
    v_perm_b32 v136, v150, v146, s85
    v_perm_b32 v137, v158, v154, s85
    v_perm_b32 v138, v150, v146, s86
    v_perm_b32 v139, v158, v154, s86
    v_perm_b32 v140, v151, v147, s85
    v_perm_b32 v141, v159, v155, s85
    v_perm_b32 v142, v151, v147, s86
    v_perm_b32 v143, v159, v155, s86
    v_perm_b32 v144, v164, v160, s85
    v_perm_b32 v145, v172, v168, s85
    v_perm_b32 v146, v164, v160, s86
    v_perm_b32 v147, v172, v168, s86
    v_perm_b32 v148, v165, v161, s85
    v_perm_b32 v149, v173, v169, s85
    v_perm_b32 v150, v165, v161, s86
    v_perm_b32 v151, v173, v169, s86
    v_perm_b32 v152, v166, v162, s85
    v_perm_b32 v153, v174, v170, s85
    v_perm_b32 v154, v166, v162, s86
    v_perm_b32 v155, v174, v170, s86
    v_perm_b32 v156, v167, v163, s85
    v_perm_b32 v157, v175, v171, s85
    v_perm_b32 v158, v167, v163, s86
    v_perm_b32 v159, v175, v171, s86
    v_perm_b32 v160, v180, v176, s85
    v_perm_b32 v161, v188, v184, s85
    v_perm_b32 v162, v180, v176, s86
    v_perm_b32 v163, v188, v184, s86
    v_perm_b32 v164, v181, v177, s85
    v_perm_b32 v165, v189, v185, s85
    v_perm_b32 v166, v181, v177, s86
    v_perm_b32 v167, v189, v185, s86
    v_perm_b32 v168, v182, v178, s85
    v_perm_b32 v169, v190, v186, s85
    v_perm_b32 v170, v182, v178, s86
    v_perm_b32 v171, v190, v186, s86
    v_perm_b32 v172, v183, v179, s85
    v_perm_b32 v173, v191, v187, s85
    v_perm_b32 v174, v183, v179, s86
    v_perm_b32 v175, v191, v187, s86
    s_cmp_ge_u32 s78, 2
    s_cbranch_scc1 L_h1_done
    s_mov_b32 s98, 20000
L_h1_check:
    s_waitcnt vmcnt(0)
    v_xor_b32 v24, s76, v99
    v_xor_b32 v25, s76, v103
    v_xor_b32 v26, s76, v107
    v_xor_b32 v27, s76, v111
    v_xor_b32 v28, s76, v115
    v_xor_b32 v29, s76, v119
    v_xor_b32 v30, s76, v123
    v_xor_b32 v31, s76, v127
    v_or3_b32 v24, v24, v25, v26
    v_or3_b32 v27, v27, v28, v29
    v_or3_b32 v24, v24, v30, v31
    v_or_b32 v24, v24, v27
    v_cmp_ne_u32 vcc, 0, v24
    s_nop 3
    s_cbranch_vccz L_h1_okA
    s_sub_u32 s98, s98, 1
    s_cbranch_scc1 L_h1_okA
    s_sleep 1
    buffer_load_dwordx4 v[96:99], v3, s[48:51], s21 offen offset:0 sc1
    buffer_load_dwordx4 v[100:103], v3, s[48:51], s21 offen offset:1024 sc1
    buffer_load_dwordx4 v[104:107], v3, s[48:51], s21 offen offset:2048 sc1
    buffer_load_dwordx4 v[108:111], v3, s[48:51], s21 offen offset:3072 sc1
    buffer_load_dwordx4 v[112:115], v3, s[48:51], s25 offen offset:0 sc1
    buffer_load_dwordx4 v[116:119], v3, s[48:51], s25 offen offset:1024 sc1
    buffer_load_dwordx4 v[120:123], v3, s[48:51], s25 offen offset:2048 sc1
    buffer_load_dwordx4 v[124:127], v3, s[48:51], s25 offen offset:3072 sc1
    s_branch L_h1_check
L_h1_okA:
    v_max3_f32 v24, v98, v102, v106
    v_max3_f32 v25, v110, v114, v118
    v_max3_f32 v24, v24, v122, v126
    v_max_f32 v24, v24, v25
    v_sub_f32 v98, v98, v24
    v_sub_f32 v102, v102, v24
    v_sub_f32 v106, v106, v24
    v_sub_f32 v110, v110, v24
    v_sub_f32 v114, v114, v24
    v_sub_f32 v118, v118, v24
    v_sub_f32 v122, v122, v24
    v_sub_f32 v126, v126, v24
    v_exp_f32 v98, v98
    v_exp_f32 v102, v102
    v_exp_f32 v106, v106
    v_exp_f32 v110, v110
    v_exp_f32 v114, v114
    v_exp_f32 v118, v118
    v_exp_f32 v122, v122
    v_exp_f32 v126, v126
    v_mul_f32 v26, v98, v96
    v_mul_f32 v27, v98, v97
    v_add_f32 v25, v98, v102
    v_fmac_f32 v26, v102, v100
    v_fmac_f32 v27, v102, v101
    v_add_f32 v25, v25, v106
    v_fmac_f32 v26, v106, v104
    v_fmac_f32 v27, v106, v105
    v_add_f32 v25, v25, v110
    v_fmac_f32 v26, v110, v108
    v_fmac_f32 v27, v110, v109
    v_add_f32 v25, v25, v114
    v_fmac_f32 v26, v114, v112
    v_fmac_f32 v27, v114, v113
    v_add_f32 v25, v25, v118
    v_fmac_f32 v26, v118, v116
    v_fmac_f32 v27, v118, v117
    v_add_f32 v25, v25, v122
    v_fmac_f32 v26, v122, v120
    v_fmac_f32 v27, v122, v121
    v_add_f32 v25, v25, v126
    v_fmac_f32 v26, v126, v124
    v_fmac_f32 v27, v126, v125
    v_rcp_f32 v25, v25
    s_nop 0
    v_mul_f32 v26, v26, v25
    v_mul_f32 v27, v27, v25
    v_cvt_pk_bf16_f32 v26, v26, v27
    ds_write_b32 v4, v26 offset:18688
    s_waitcnt lgkmcnt(0)
L_h1_done:
    s_barrier
    ds_read_b128 v[24:27], v5 offset:18688
    ds_read_b128 v[32:35], v5 offset:18944
    ds_read_b128 v[28:31], v5 offset:18704
    ds_read_b128 v[36:39], v5 offset:18960
    v_mov_b32 v42, s76
    v_mov_b32 v43, s77
    s_waitcnt vmcnt(0) lgkmcnt(0)
    v_mfma_f32_4x4x4_16b_bf16 v[64:67], v[24:25], v[240:241], 0
    v_mfma_f32_4x4x4_16b_bf16 v[68:71], v[24:25], v[242:243], 0
    v_mfma_f32_4x4x4_16b_bf16 v[72:75], v[24:25], v[244:245], 0
    v_mfma_f32_4x4x4_16b_bf16 v[76:79], v[24:25], v[246:247], 0
    v_mfma_f32_4x4x4_16b_bf16 v[80:83], v[24:25], v[248:249], 0
    v_mfma_f32_4x4x4_16b_bf16 v[84:87], v[24:25], v[250:251], 0
    v_mfma_f32_4x4x4_16b_bf16 v[88:91], v[24:25], v[252:253], 0
    v_mfma_f32_4x4x4_16b_bf16 v[92:95], v[24:25], v[254:255], 0
    v_mfma_f32_4x4x4_16b_bf16 v[96:99], v[32:33], v[48:49], 0
    v_mfma_f32_4x4x4_16b_bf16 v[100:103], v[32:33], v[50:51], 0
    v_mfma_f32_4x4x4_16b_bf16 v[104:107], v[32:33], v[52:53], 0
    v_mfma_f32_4x4x4_16b_bf16 v[108:111], v[32:33], v[54:55], 0
    v_mfma_f32_4x4x4_16b_bf16 v[112:115], v[32:33], v[56:57], 0
    v_mfma_f32_4x4x4_16b_bf16 v[116:119], v[32:33], v[58:59], 0
    v_mfma_f32_4x4x4_16b_bf16 v[120:123], v[32:33], v[60:61], 0
    v_mfma_f32_4x4x4_16b_bf16 v[124:127], v[32:33], v[62:63], 0
    v_mfma_f32_4x4x4_16b_bf16 v[64:67], v[26:27], v[128:129], v[64:67]
    v_mfma_f32_4x4x4_16b_bf16 v[68:71], v[26:27], v[130:131], v[68:71]
    v_mfma_f32_4x4x4_16b_bf16 v[72:75], v[26:27], v[132:133], v[72:75]
    v_mfma_f32_4x4x4_16b_bf16 v[76:79], v[26:27], v[134:135], v[76:79]
    v_mfma_f32_4x4x4_16b_bf16 v[80:83], v[26:27], v[136:137], v[80:83]
    v_mfma_f32_4x4x4_16b_bf16 v[84:87], v[26:27], v[138:139], v[84:87]
    v_mfma_f32_4x4x4_16b_bf16 v[88:91], v[26:27], v[140:141], v[88:91]
    v_mfma_f32_4x4x4_16b_bf16 v[92:95], v[26:27], v[142:143], v[92:95]
    v_mfma_f32_4x4x4_16b_bf16 v[96:99], v[34:35], v[192:193], v[96:99]
    v_mfma_f32_4x4x4_16b_bf16 v[100:103], v[34:35], v[194:195], v[100:103]
    v_mfma_f32_4x4x4_16b_bf16 v[104:107], v[34:35], v[196:197], v[104:107]
    v_mfma_f32_4x4x4_16b_bf16 v[108:111], v[34:35], v[198:199], v[108:111]
    v_mfma_f32_4x4x4_16b_bf16 v[112:115], v[34:35], v[200:201], v[112:115]
    v_mfma_f32_4x4x4_16b_bf16 v[116:119], v[34:35], v[202:203], v[116:119]
    v_mfma_f32_4x4x4_16b_bf16 v[120:123], v[34:35], v[204:205], v[120:123]
    v_mfma_f32_4x4x4_16b_bf16 v[124:127], v[34:35], v[206:207], v[124:127]
    v_mfma_f32_4x4x4_16b_bf16 v[64:67], v[28:29], v[144:145], v[64:67]
    v_mfma_f32_4x4x4_16b_bf16 v[68:71], v[28:29], v[146:147], v[68:71]
    v_mfma_f32_4x4x4_16b_bf16 v[72:75], v[28:29], v[148:149], v[72:75]
    v_mfma_f32_4x4x4_16b_bf16 v[76:79], v[28:29], v[150:151], v[76:79]
    v_mfma_f32_4x4x4_16b_bf16 v[80:83], v[28:29], v[152:153], v[80:83]
    v_mfma_f32_4x4x4_16b_bf16 v[84:87], v[28:29], v[154:155], v[84:87]
    v_mfma_f32_4x4x4_16b_bf16 v[88:91], v[28:29], v[156:157], v[88:91]
    v_mfma_f32_4x4x4_16b_bf16 v[92:95], v[28:29], v[158:159], v[92:95]
    v_mfma_f32_4x4x4_16b_bf16 v[96:99], v[36:37], v[208:209], v[96:99]
    v_mfma_f32_4x4x4_16b_bf16 v[100:103], v[36:37], v[210:211], v[100:103]
    v_mfma_f32_4x4x4_16b_bf16 v[104:107], v[36:37], v[212:213], v[104:107]
    v_mfma_f32_4x4x4_16b_bf16 v[108:111], v[36:37], v[214:215], v[108:111]
    v_mfma_f32_4x4x4_16b_bf16 v[112:115], v[36:37], v[216:217], v[112:115]
    v_mfma_f32_4x4x4_16b_bf16 v[116:119], v[36:37], v[218:219], v[116:119]
    v_mfma_f32_4x4x4_16b_bf16 v[120:123], v[36:37], v[220:221], v[120:123]
    v_mfma_f32_4x4x4_16b_bf16 v[124:127], v[36:37], v[222:223], v[124:127]
    v_mfma_f32_4x4x4_16b_bf16 v[64:67], v[30:31], v[160:161], v[64:67]
    v_mfma_f32_4x4x4_16b_bf16 v[68:71], v[30:31], v[162:163], v[68:71]
    v_mfma_f32_4x4x4_16b_bf16 v[72:75], v[30:31], v[164:165], v[72:75]
    v_mfma_f32_4x4x4_16b_bf16 v[76:79], v[30:31], v[166:167], v[76:79]
    v_mfma_f32_4x4x4_16b_bf16 v[80:83], v[30:31], v[168:169], v[80:83]
    v_mfma_f32_4x4x4_16b_bf16 v[84:87], v[30:31], v[170:171], v[84:87]
    v_mfma_f32_4x4x4_16b_bf16 v[88:91], v[30:31], v[172:173], v[88:91]
    v_mfma_f32_4x4x4_16b_bf16 v[92:95], v[30:31], v[174:175], v[92:95]
    v_mfma_f32_4x4x4_16b_bf16 v[96:99], v[38:39], v[224:225], v[96:99]
    v_mfma_f32_4x4x4_16b_bf16 v[100:103], v[38:39], v[226:227], v[100:103]
    v_mfma_f32_4x4x4_16b_bf16 v[104:107], v[38:39], v[228:229], v[104:107]
    v_mfma_f32_4x4x4_16b_bf16 v[108:111], v[38:39], v[230:231], v[108:111]
    v_mfma_f32_4x4x4_16b_bf16 v[112:115], v[38:39], v[232:233], v[112:115]
    v_mfma_f32_4x4x4_16b_bf16 v[116:119], v[38:39], v[234:235], v[116:119]
    v_mfma_f32_4x4x4_16b_bf16 v[120:123], v[38:39], v[236:237], v[120:123]
    v_mfma_f32_4x4x4_16b_bf16 v[124:127], v[38:39], v[238:239], v[124:127]
    v_permlane32_swap_b32 v64, v80
    v_permlane32_swap_b32 v68, v84
    v_permlane32_swap_b32 v72, v88
    v_permlane32_swap_b32 v76, v92
    v_permlane32_swap_b32 v96, v112
    v_permlane32_swap_b32 v100, v116
    v_permlane32_swap_b32 v104, v120
    v_permlane32_swap_b32 v108, v124
    v_add_f32 v64, v64, v80
    v_add_f32 v68, v68, v84
    v_add_f32 v72, v72, v88
    v_add_f32 v76, v76, v92
    v_add_f32 v96, v96, v112
    v_add_f32 v100, v100, v116
    v_add_f32 v104, v104, v120
    v_add_f32 v108, v108, v124
    v_permlane16_swap_b32 v64, v72
    v_permlane16_swap_b32 v68, v76
    v_permlane16_swap_b32 v96, v104
    v_permlane16_swap_b32 v100, v108
    v_add_f32 v64, v64, v72
    v_add_f32 v68, v68, v76
    v_add_f32 v96, v96, v104
    v_add_f32 v100, v100, v108
    v_add_f32_dpp v40, v64, v64 row_ror:8 row_mask:0xf bank_mask:0x3
    v_add_f32_dpp v40, v68, v68 row_ror:8 row_mask:0xf bank_mask:0xc
    v_add_f32_dpp v41, v96, v96 row_ror:8 row_mask:0xf bank_mask:0x3
    v_add_f32_dpp v41, v100, v100 row_ror:8 row_mask:0xf bank_mask:0xc
    buffer_store_dwordx4 v[40:43], v6, s[48:51], s22 offen sc1
    s_cmp_lg_u32 s78, 0
    s_cbranch_scc1 L_end
    s_mov_b32 s98, 20000
L_h2_poll:
    buffer_load_dwordx4 v[48:51], v3, s[48:51], s23 offen offset:0 sc1
    buffer_load_dwordx4 v[52:55], v3, s[48:51], s23 offen offset:1024 sc1
    buffer_load_dwordx4 v[56:59], v3, s[48:51], s23 offen offset:2048 sc1
    buffer_load_dwordx4 v[60:63], v3, s[48:51], s23 offen offset:3072 sc1
    s_waitcnt vmcnt(0)
    v_xor_b32 v24, s76, v50
    v_xor_b32 v25, s77, v51
    v_xor_b32 v26, s76, v54
    v_xor_b32 v27, s77, v55
    v_xor_b32 v28, s76, v58
    v_xor_b32 v29, s77, v59
    v_xor_b32 v30, s76, v62
    v_xor_b32 v31, s77, v63
    v_or3_b32 v24, v24, v25, v26
    v_or3_b32 v27, v27, v28, v29
    v_or3_b32 v24, v24, v30, v31
    v_or_b32 v24, v24, v27
    v_cmp_ne_u32 vcc, 0, v24
    s_nop 3
    s_cbranch_vccz L_h2_okA
    s_sub_u32 s98, s98, 1
    s_cbranch_scc1 L_h2_okA
    s_sleep 1
    s_branch L_h2_poll
L_h2_okA:
    v_add_f32 v24, v48, v52
    v_add_f32 v25, v49, v53
    v_add_f32 v26, v56, v60
    v_add_f32 v27, v57, v61
    v_add_f32 v24, v24, v26
    v_add_f32 v25, v25, v27
    s_nop 0
    v_add_f32_dpp v24, v24, v24 row_ror:8 row_mask:0xf bank_mask:0xf
    v_add_f32_dpp v25, v25, v25 row_ror:8 row_mask:0xf bank_mask:0xf
    v_mov_b32 v26, v24
    v_mov_b32 v27, v25
    s_nop 0
    v_permlane16_swap_b32 v24, v26
    v_permlane16_swap_b32 v25, v27
    v_add_f32 v24, v24, v26
    v_add_f32 v25, v25, v27
    v_mov_b32 v26, v24
    v_mov_b32 v27, v25
    s_nop 0
    v_permlane32_swap_b32 v24, v26
    v_permlane32_swap_b32 v25, v27
    v_add_f32 v24, v24, v26
    v_add_f32 v25, v25, v27
    v_cvt_pk_bf16_f32 v24, v24, v25
    v_lshlrev_b32 v25, 16, v24
    v_and_b32 v24, 0xffff0000, v24
    v_mul_f32 v25, s95, v25
    v_mul_f32 v24, s96, v24
    v_cvt_pk_bf16_f32 v24, v25, v24
    v_lshlrev_b32 v25, 16, v24
    v_and_b32 v24, 0xffff0000, v24
    v_add_f32 v24, v24, v25
    v_cvt_pk_bf16_f32 v24, v24, v24
    buffer_store_short v24, v7, s[68:71], s24 offen
    s_cmp_lg_u32 s2, 0
    s_cbranch_scc1 L_end
    v_mov_b32 v25, s76
    buffer_store_dword v25, v21, s[48:51], 0 offen sc1
L_end:
    s_endpgm
.section .rodata,"a"
.p2align 6
.amdhsa_kernel gated_mix__sliding_block_cached__gqa_block_cached__decode_kernel
  .amdhsa_next_free_vgpr 352
  .amdhsa_next_free_sgpr 102
  .amdhsa_accum_offset 256
  .amdhsa_group_segment_fixed_size 0
  .amdhsa_kernarg_size 112
  .amdhsa_user_sgpr_count 2
  .amdhsa_user_sgpr_kernarg_segment_ptr 1
  .amdhsa_system_sgpr_workgroup_id_x 1
.end_amdhsa_kernel
```
